```python
import torch

def _softmax(x, axis=-1):
    return torch.softmax(x, dim=axis)
def _gelu(x):
    return torch.nn.functional.gelu(x, approximate="tanh")
def _silu(x):
    return torch.nn.functional.silu(x)
def _sigmoid(x):
    return torch.sigmoid(x)
def _layernorm(x, axis=-1, eps=1e-5):
    m = x.mean(dim=axis, keepdim=True)
    v = x.var(dim=axis, keepdim=True, unbiased=False)
    return (x - m) / torch.sqrt(v + eps)
def _scatter_add(tgt, idx, src, axis=0):
    return tgt.clone().index_add_(axis, idx, src)
def _segment_sum(src, seg, n):
    out = torch.zeros((n,) + src.shape[1:], dtype=src.dtype)
    return out.index_add_(0, seg, src)
def _pad(x, pw):
    flat = tuple(v for pair in reversed(pw) for v in pair)
    return torch.nn.functional.pad(x, flat)

kernel_name = 'interleave_layers__sliding_block_cached__dense_activation_mish__decode'

def setup_inputs():

    _w = (lambda a: (lambda t: t.to(torch.bfloat16) if t.is_floating_point() else t)(torch.as_tensor(a)))
    def _A_setup():
        B, Sq, D = 1, 1, 576
        Hq, Hkv, Sk, Dh = 32, 16, 32768, 128
        assert Hq % Hkv == 0, (Hq, Hkv)
        return {
            "x": _w((lambda *s: torch.randn(*s, dtype=torch.bfloat16) * 0.05)(B, Sq, D)),
            "k_cache": _w((lambda *s: torch.randn(*s, dtype=torch.bfloat16) * 1.6)(B, Hkv, Sk, Dh)),
            "v_cache": _w((lambda *s: torch.randn(*s, dtype=torch.bfloat16) * 1.6)(B, Hkv, Sk, Dh)),
            "wq": _w((lambda *s: torch.randn(*s, dtype=torch.bfloat16) * 1.6)(D, Hq * Dh) * (D ** -0.5)),
            "wo": _w((lambda *s: torch.randn(*s, dtype=torch.bfloat16) * 1.6)(Hq * Dh, D) * ((Hq * Dh) ** -0.5)),
        }
    _A_in = _A_setup()

    def _B_setup():
        B, S, D, F = 1, 1, 576, 4608
        return {
            "x": _w((lambda *s: torch.randn(*s, dtype=torch.bfloat16) * 0.05)(B, S, D)),
            "w1": _w((lambda *s: torch.randn(*s, dtype=torch.bfloat16) * 0.8)(D, F) * (D ** -0.5)),
            "b1": _w((lambda *s: torch.randn(*s, dtype=torch.bfloat16) * 0.8)(F)),
            "w2": _w((lambda *s: torch.randn(*s, dtype=torch.bfloat16) * 0.8)(F, D) * (F ** -0.5)),
        }
    _B_in = _B_setup()

    return {
        "A_x": _A_in["x"],
        "A_k_cache": _A_in["k_cache"],
        "A_v_cache": _A_in["v_cache"],
        "A_wq": _A_in["wq"],
        "A_wo": _A_in["wo"],
        "B_x": _B_in["x"],
        "B_w1": _B_in["w1"],
        "B_b1": _B_in["b1"],
        "B_w2": _B_in["w2"],
    }

def reference(A_x, A_k_cache, A_v_cache, A_wq, A_wo, B_x, B_w1, B_b1, B_w2):
    def _A_ref(x, k_cache, v_cache, wq, wo):
        B, Sq, D = x.shape
        Hq, Dh = 32, 128
        Hkv, Sk = k_cache.shape[1], k_cache.shape[2]
        W = min(4096, max(256, Sk // 4))
        rep = Hq // Hkv
        q = (lambda x, *d: x.permute(*d))((x @ wq).reshape(B, Sq, Hq, Dh), 0, 2, 1, 3)
        k = (lambda x, n, axis: torch.repeat_interleave(x, n, dim=axis))(k_cache[:, :, Sk - W:, :], rep, axis=1)
        v = (lambda x, n, axis: torch.repeat_interleave(x, n, dim=axis))(v_cache[:, :, Sk - W:, :], rep, axis=1)
        scores = torch.einsum("bhqd,bhkd->bhqk", q, k) * (Dh ** -0.5)
        p = _softmax(scores, axis=-1)
        o = torch.einsum("bhqk,bhkd->bhqd", p, v)
        return (lambda x, *d: x.permute(*d))(o, 0, 2, 1, 3).reshape(B, Sq, Hq * Dh) @ wo

    def _B_ref(x, w1, b1, w2):
        h = torch.einsum("bsd,df->bsf", x, w1) + b1
        sp = torch.log1p(torch.exp(-torch.abs(h))) + torch.where(h > 0, h, torch.zeros_like(h))
        act = h * torch.tanh(sp)
        return torch.einsum("bsf,fd->bsd", act, w2)

    x = A_x
    x = x + _A_ref(_layernorm(x, axis=-1), A_k_cache, A_v_cache, A_wq, A_wo)
    x = x + _B_ref(_layernorm(x, axis=-1), B_w1, B_b1, B_w2)
    x = x + _A_ref(_layernorm(x, axis=-1), A_k_cache, A_v_cache, A_wq, A_wo)
    x = x + _B_ref(_layernorm(x, axis=-1), B_w1, B_b1, B_w2)
    return x
```

```asm
; @launch grid=(256,1,1) block=(256,1,1) lds=163840
.amdgcn_target "amdgcn-amd-amdhsa--gfx950"
.text
.globl interleave_layers__sliding_block_cached__dense_activation_mish__decode_kernel
.p2align 12
.fill 1, 4, 0xbf810000
.p2align 8
.type interleave_layers__sliding_block_cached__dense_activation_mish__decode_kernel,@function
interleave_layers__sliding_block_cached__dense_activation_mish__decode_kernel:
s_cmp_ge_u32 s2, 256
s_cbranch_scc1 L_end
s_load_dwordx2 s[20:21], s[0:1], 24
s_load_dwordx2 s[36:37], s[0:1], 0
s_load_dwordx4 s[12:15], s[0:1], 8
s_cmp_lt_u32 s2, 248
s_cbranch_scc1 L_nopf
s_getpc_b64 s[100:101]
L_pc:
v_min_u32 v8, 143, v0
v_lshlrev_b32 v8, 7, v8
global_load_dword v8, v8, s[100:101]
L_nopf:
s_lshr_b32 s5, s2, 3
v_readfirstlane_b32 s6, v0
v_lshrrev_b32 v65, 3, v0
v_lshrrev_b32 v3, 4, v0
s_mul_i32 s62, s5, 37
v_and_b32 v64, 2, v65
s_lshr_b32 s62, s62, 8
v_and_or_b32 v64, v3, 4, v64
s_mul_i32 s52, s62, 7
v_xor_b32 v64, v64, v0
s_sub_u32 s63, s5, s52
v_and_b32 v64, 7, v64
s_cmp_ge_u32 s63, 3
v_lshlrev_b32 v64, 4, v64
s_addc_u32 s52, s63, 0
v_and_b32 v65, 7, v65
s_cmp_ge_u32 s5, 28
v_lshl_or_b32 v64, v65, 13, v64
s_cselect_b32 s62, s63, s62
s_cselect_b32 s63, 3, s52
v_and_b32 v1, 63, v0
s_and_b32 s4, s2, 7
s_mul_i32 s53, s62, 9216
s_lshl_b32 s54, s6, 3
s_add_u32 s53, s53, s54
s_lshl_b32 s54, s4, 3
s_add_u32 s53, s53, s54
s_add_u32 s53, s53, s63
s_lshl_b32 s53, s53, 7
s_lshl_b32 s67, s6, 4
s_add_u32 s54, s67, 135168
s_mov_b32 s23, 0x20000
s_mov_b32 s22, 4718592
s_mov_b32 s39, s23
s_movk_i32 s38, 1152
s_lshr_b32 s6, s6, 6
s_cmp_lg_u32 s6, 2
v_lshlrev_b32 v66, 4, v1
s_waitcnt lgkmcnt(0)
s_cbranch_scc1 L_nox0
buffer_load_dwordx4 v[192:195], v66, s[36:39], 0 offen
buffer_load_dwordx4 v[196:199], v66, s[36:39], 0 offen offset:1024
L_nox0:
s_add_u32 m0, s54, 0
s_cmp_ge_u32 s6, 2
buffer_load_dwordx4 v64, s[20:23], s53 offen nt lds
s_add_u32 m0, s54, 4096
s_add_u32 s53, s53, 262144
buffer_load_dwordx4 v64, s[20:23], s53 offen nt lds
s_add_u32 m0, s54, 8192
s_add_u32 s53, s53, 262144
buffer_load_dwordx4 v64, s[20:23], s53 offen nt lds
s_add_u32 m0, s54, 12288
s_add_u32 s53, s53, 262144
buffer_load_dwordx4 v64, s[20:23], s53 offen nt lds
s_cmp_ge_u32 s6, 2
s_cbranch_scc1 L_wq4
s_add_u32 m0, s54, 16384
s_add_u32 s53, s53, 262144
buffer_load_dwordx4 v64, s[20:23], s53 offen nt lds
L_wq4:
s_load_dwordx2 s[32:33], s[0:1], 88
v_and_b32 v2, 15, v0
v_and_b32 v10, 15, v3
s_lshl_b32 s55, s4, 24
v_xor_b32 v10, v10, v2
s_lshr_b32 s52, s5, 4
v_lshlrev_b32 v10, 4, v10
s_mul_i32 s52, s52, 7340032
v_and_b32 v3, 3, v3
s_lshl_b32 s53, s5, 16
v_lshl_or_b32 v10, v3, 8, v10
s_add_u32 s52, s52, s55
s_add_u32 s52, s52, s53
s_add_u32 s57, s52, 7274496
s_lshl_b32 s98, s4, 13
s_add_u32 s66, s67, s98
s_add_u32 s66, s66, 65536
s_add_u32 s16, s14, s57
s_addc_u32 s17, s15, 0
s_add_u32 s12, s12, s57
s_addc_u32 s13, s13, 0
s_mov_b32 s14, 131072
s_mov_b32 s15, 0x20000
s_xor_b32 m0, s66, 0
s_nop 0
buffer_load_dwordx4 v10, s[12:15], m0 offen nt lds
s_xor_b32 m0, s66, 4096
s_nop 0
buffer_load_dwordx4 v10, s[12:15], m0 offen nt lds
s_xor_b32 m0, s66, 8192
s_nop 0
buffer_load_dwordx4 v10, s[12:15], m0 offen nt lds
s_xor_b32 m0, s66, 12288
s_nop 0
buffer_load_dwordx4 v10, s[12:15], m0 offen nt lds
s_xor_b32 m0, s66, 16384
s_nop 0
buffer_load_dwordx4 v10, s[12:15], m0 offen nt lds
s_xor_b32 m0, s66, 20480
s_nop 0
buffer_load_dwordx4 v10, s[12:15], m0 offen nt lds
s_waitcnt lgkmcnt(0)
s_mov_b32 s34, 2097152
s_mov_b32 s35, 0x20000
s_add_u32 s16, s16, 65536
s_addc_u32 s17, s17, 0
s_and_b32 s52, s98, 0x7000
s_add_u32 s67, s67, s52
s_load_dwordx2 s[24:25], s[0:1], 32
s_load_dwordx2 s[92:93], s[0:1], 48
s_load_dwordx2 s[40:41], s[0:1], 56
s_load_dwordx2 s[28:29], s[0:1], 64
s_load_dwordx2 s[44:45], s[0:1], 72
s_mov_b32 s53, 983040
s_buffer_load_dword s68, s[32:35], s53
s_lshl_b32 s11, s4, 16
s_add_u32 s11, s11, 131072
s_mul_i32 s69, s4, 36864
s_add_u32 s69, s69, 655360
s_mov_b32 s7, 0
v_bfe_u32 v64, v1, 3, 2
v_xor_b32 v64, s6, v64
v_lshlrev_b32 v64, 5, v64
v_and_b32 v65, 3, v1
v_lshl_add_u32 v64, v65, 3, v64
v_bfe_u32 v65, v1, 2, 2
v_lshl_add_u32 v64, v65, 7, v64
v_lshl_add_u32 v64, v3, 10, v64
v_add_u32 v64, 135168, v64
v_bfe_u32 v66, v1, 3, 1
v_and_b32 v67, 2, v3
v_or_b32 v66, v66, v67
v_xor_b32 v66, s6, v66
v_lshlrev_b32 v66, 5, v66
v_and_b32 v67, 3, v1
v_lshl_add_u32 v66, v67, 3, v66
v_lshrrev_b32 v67, 2, v1
v_lshl_add_u32 v66, v67, 7, v66
v_add_u32 v66, 151552, v66
v_mov_b32 v88, 0
v_mov_b32 v89, 0
v_mov_b32 v90, 0
v_mov_b32 v91, 0
v_lshlrev_b32 v30, 4, v0
v_add_u32 v30, 158848, v30
ds_write_b128 v30, v[88:91] offset:512
v_mul_u32_u24 v31, 288, v2
v_lshl_add_u32 v32, v3, 3, v31
v_add_u32 v32, 159104, v32
v_lshl_add_u32 v31, v3, 4, v31
v_add_u32 v31, 158848, v31
v_mov_b32 v33, v31
v_mov_b32 v34, v31
s_lshl_b32 s52, s63, 10
s_lshl_b32 s53, s6, 8
s_add_u32 s52, s52, s53
s_lshl_b32 s53, s62, 2
s_add_u32 s52, s52, s53
v_lshl_add_u32 v35, v2, 4, s52
s_cmp_lg_u32 s6, 2
s_cbranch_scc1 L_pwx
v_mov_b32 v244, 0
v_mov_b32 v245, 0
v_mov_b32 v246, 0x3f803f80
v_lshlrev_b32 v68, 4, v1
v_add_u32 v68, 158848, v68
s_mov_b32 exec_lo, 0xfffc0000
s_mov_b32 exec_hi, 0
ds_write_b128 v68, v[88:91]
s_mov_b64 exec, -1
s_mul_i32 s52, s62, 18
s_lshl_b32 s53, s52, 4
v_subrev_u32 v69, s53, v68
s_mov_b64 s[54:55], 0x3ffff
s_lshl_b64 s[54:55], s[54:55], s52
s_waitcnt vmcnt(10)
v_dot2c_f32_bf16 v244, v192, v246
v_dot2c_f32_bf16 v245, v192, v192
v_dot2c_f32_bf16 v244, v193, v246
v_dot2c_f32_bf16 v245, v193, v193
v_dot2c_f32_bf16 v244, v194, v246
v_dot2c_f32_bf16 v245, v194, v194
v_dot2c_f32_bf16 v244, v195, v246
v_dot2c_f32_bf16 v245, v195, v195
v_dot2c_f32_bf16 v244, v196, v246
v_dot2c_f32_bf16 v245, v196, v196
v_dot2c_f32_bf16 v244, v197, v246
v_dot2c_f32_bf16 v245, v197, v197
v_dot2c_f32_bf16 v244, v198, v246
v_dot2c_f32_bf16 v245, v198, v198
v_dot2c_f32_bf16 v244, v199, v246
v_dot2c_f32_bf16 v245, v199, v199
v_lshlrev_b32 v104, 16, v192
v_and_b32 v105, 0xffff0000, v192
v_lshlrev_b32 v106, 16, v193
v_and_b32 v107, 0xffff0000, v193
v_lshlrev_b32 v108, 16, v194
v_and_b32 v109, 0xffff0000, v194
v_lshlrev_b32 v110, 16, v195
v_and_b32 v111, 0xffff0000, v195
v_add_f32_dpp v244, v244, v244 quad_perm:[1,0,3,2] row_mask:0xf bank_mask:0xf
v_add_f32_dpp v245, v245, v245 quad_perm:[1,0,3,2] row_mask:0xf bank_mask:0xf
s_nop 0
v_add_f32_dpp v244, v244, v244 quad_perm:[2,3,0,1] row_mask:0xf bank_mask:0xf
v_add_f32_dpp v245, v245, v245 quad_perm:[2,3,0,1] row_mask:0xf bank_mask:0xf
s_nop 0
v_add_f32_dpp v244, v244, v244 row_half_mirror row_mask:0xf bank_mask:0xf
v_add_f32_dpp v245, v245, v245 row_half_mirror row_mask:0xf bank_mask:0xf
s_nop 0
v_add_f32_dpp v244, v244, v244 row_mirror row_mask:0xf bank_mask:0xf
v_add_f32_dpp v245, v245, v245 row_mirror row_mask:0xf bank_mask:0xf
v_mov_b32 v246, v244
v_mov_b32 v247, v245
s_nop 0
v_permlane16_swap_b32 v244, v246
v_permlane16_swap_b32 v245, v247
v_add_f32 v244, v244, v246
v_add_f32 v245, v245, v247
v_mov_b32 v246, v244
v_mov_b32 v247, v245
s_nop 0
v_permlane32_swap_b32 v244, v246
v_permlane32_swap_b32 v245, v247
v_add_f32 v244, v244, v246
v_add_f32 v245, v245, v247
v_mul_f32 v246, 1.736111111e-03, v244
v_sub_f32 v104, v104, v246
v_sub_f32 v105, v105, v246
v_sub_f32 v106, v106, v246
v_sub_f32 v107, v107, v246
v_sub_f32 v108, v108, v246
v_sub_f32 v109, v109, v246
v_sub_f32 v110, v110, v246
v_sub_f32 v111, v111, v246
v_cvt_pk_bf16_f32 v104, v104, v105
v_cvt_pk_bf16_f32 v105, v106, v107
v_cvt_pk_bf16_f32 v106, v108, v109
v_cvt_pk_bf16_f32 v107, v110, v111
v_fma_f32 v245, -v246, v244, v245
v_mov_b32 v247, 158784
v_mul_f32 v245, 0x3d800000, v245
s_mov_b64 exec, s[54:55]
ds_write_b128 v69, v[104:107]
ds_write2_b32 v247, v245, v88 offset0:0 offset1:1
s_mov_b64 exec, -1
s_cmp_lg_u32 s62, 3
s_cbranch_scc1 L_x0d
v_lshlrev_b32 v112, 16, v196
v_and_b32 v113, 0xffff0000, v196
v_lshlrev_b32 v114, 16, v197
v_and_b32 v115, 0xffff0000, v197
v_lshlrev_b32 v116, 16, v198
v_and_b32 v117, 0xffff0000, v198
v_lshlrev_b32 v118, 16, v199
v_and_b32 v119, 0xffff0000, v199
v_sub_f32 v112, v112, v246
v_sub_f32 v113, v113, v246
v_sub_f32 v114, v114, v246
v_sub_f32 v115, v115, v246
v_sub_f32 v116, v116, v246
v_sub_f32 v117, v117, v246
v_sub_f32 v118, v118, v246
v_sub_f32 v119, v119, v246
v_cvt_pk_bf16_f32 v112, v112, v113
v_cvt_pk_bf16_f32 v113, v114, v115
v_cvt_pk_bf16_f32 v114, v116, v117
v_cvt_pk_bf16_f32 v115, v118, v119
s_mov_b64 exec, 0xff
ds_write_b128 v68, v[112:115] offset:160
s_mov_b64 exec, -1
L_x0d:
s_xor_b32 m0, s66, 24576
s_nop 0
buffer_load_dwordx4 v10, s[12:15], m0 offen nt lds
s_xor_b32 m0, s66, 28672
s_nop 0
buffer_load_dwordx4 v10, s[12:15], m0 offen nt lds
s_waitcnt vmcnt(8)
L_bar1:
s_waitcnt lgkmcnt(0)
s_barrier
ds_read_b64_tr_b16 a[64:65], v64 offset:0
ds_read_b64_tr_b16 a[66:67], v64 offset:512
ds_read_b64_tr_b16 a[68:69], v64 offset:4096
ds_read_b64_tr_b16 a[70:71], v64 offset:4608
ds_read_b64_tr_b16 a[72:73], v64 offset:8192
ds_read_b64_tr_b16 a[74:75], v64 offset:8704
ds_read_b64_tr_b16 a[76:77], v64 offset:12288
ds_read_b64_tr_b16 a[78:79], v64 offset:12800
ds_read_b64_tr_b16 a[80:81], v66 offset:0
s_and_b32 s68, s68, -16
s_add_u32 s68, s68, 16
s_branch L_q_reads
L_pwx:
s_cmp_eq_u32 s6, 3
s_cbranch_scc1 L_pw3
s_xor_b32 m0, s66, 24576
s_nop 0
buffer_load_dwordx4 v10, s[12:15], m0 offen nt lds
s_xor_b32 m0, s66, 28672
s_nop 0
buffer_load_dwordx4 v10, s[12:15], m0 offen nt lds
s_cmp_eq_u32 s6, 0
s_cbranch_scc1 L_walk0_0
s_branch L_walk1_0
L_walked:
s_waitcnt vmcnt(8)
s_branch L_bar1
L_pw3:
v_mov_b32 v240, -1
v_mov_b32 v241, -1
v_mov_b32 v242, -1
v_mov_b32 v243, -1
s_mul_i32 s53, s5, 896
v_lshl_add_u32 v70, v1, 4, s53
s_lshl_b32 s53, s5, 9
s_add_u32 s53, s53, 28672
v_lshl_add_u32 v71, v1, 4, s53
s_lshl_b32 s53, s5, 6
s_add_u32 s53, s53, 44544
v_lshl_add_u32 v72, v1, 4, s53
v_cmp_gt_u32 vcc, 32, v1
s_lshl_b32 s53, s2, 9
v_lshl_add_u32 v73, v1, 4, s53
v_cndmask_b32 v71, v72, v71, vcc
s_lshr_b32 s53, s2, 6
s_lshl_b32 s53, s53, 14
s_and_b32 s54, s2, 63
s_lshl_b32 s54, s54, 7
s_add_u32 s53, s53, s54
s_add_u32 s53, s53, 1835008
v_lshl_add_u32 v72, v1, 4, s53
v_lshrrev_b32 v74, 3, v1
v_mul_u32_u24 v74, 8064, v74
v_add_u32 v72, v72, v74
s_mov_b32 exec_hi, 0xf
buffer_store_dwordx4 v[240:243], v71, s[32:35], s11 offen sc1
s_mov_b32 exec_hi, 0xffffff
buffer_store_dwordx4 v[240:243], v70, s[32:35], s11 offen sc1
s_and_b32 s53, s2, 3
s_cmp_eq_u32 s53, 2
s_cselect_b32 s54, 0xff, -1
s_cmp_eq_u32 s53, 3
s_cselect_b32 exec_lo, 1, s54
s_mov_b32 exec_hi, 0
buffer_store_dwordx4 v[240:243], v73, s[32:35], 0 offen sc1
s_mov_b32 exec_lo, 0xffff
buffer_store_dwordx4 v[240:243], v72, s[32:35], 0 offen sc1
s_mov_b64 exec, -1
s_xor_b32 m0, s66, 24576
s_nop 0
buffer_load_dwordx4 v10, s[12:15], m0 offen nt lds
s_xor_b32 m0, s66, 28672
s_nop 0
buffer_load_dwordx4 v10, s[12:15], m0 offen nt lds
s_waitcnt vmcnt(12)
s_branch L_bar1
L_walk1_0:
s_branch L_walk1_1
L_q:
v_and_b32 v254, 7, v2
v_lshlrev_b32 v254, 2, v254
v_add_u32 v254, 1785856, v254
s_add_u32 s59, s10, 65536
s_mov_b32 s57, 0
s_cmp_lg_u32 s6, 0
s_cbranch_scc1 L_xo1
s_barrier
s_mov_b32 s57, 0
L_poll3:
buffer_load_dwordx4 v[192:195], v28, s[32:35], s59 offen sc1
buffer_load_dwordx4 v[196:199], v29, s[32:35], s59 offen sc1
s_add_u32 s57, s57, 1
s_cmp_gt_u32 s57, 1048576
s_cbranch_scc1 L_end
s_waitcnt vmcnt(0)
ds_write_b128 v30, v[192:195]
s_mov_b32 exec_hi, 0
ds_write_b128 v30, v[196:199] offset:4096
s_mov_b32 exec_hi, -1
v_max_u32 v240, v192, v193
v_max3_u32 v240, v240, v194, v195
v_max3_u32 v240, v240, v196, v197
v_max3_u32 v240, v240, v198, v199
v_cmp_eq_u32 vcc, -1, v240
s_cbranch_vccnz L_poll3
s_branch L_xj2
L_walk1_1:
s_branch L_walk1_2
L_xo1:
v_mov_b32 v252, s68
s_cmp_lg_u32 s6, 3
s_cbranch_scc1 L_hs4
s_mov_b32 s57, 0
buffer_load_dword v232, v46, s[32:35], s58 offen offset:128 sc1
s_nop 7
s_nop 7
s_nop 7
.p2align 6
s_nop 0
s_nop 0
s_nop 0
s_nop 0
s_nop 0
s_nop 0
s_nop 0
s_nop 0
s_nop 0
s_nop 0
s_nop 0
L_poll5:
buffer_load_dword v232, v46, s[32:35], s58 offen offset:128 sc1
s_add_u32 s57, s57, 1
s_cmp_gt_u32 s57, 1048576
s_cbranch_scc1 L_end
s_waitcnt vmcnt(1)
v_cmp_eq_u32 vcc, -1, v232
s_cbranch_vccnz L_poll5
L_hs4:
s_barrier
s_cmp_eq_u32 s6, 1
L_xq1_top:
buffer_load_dwordx4 v[192:195], v28, s[32:35], s59 offen sc1
s_cbranch_scc0 L_xq1_a
buffer_load_dword v252, v254, s[32:35], s10 offen sc1
L_xq1_a:
s_add_u32 s57, s57, 1
s_cmp_gt_u32 s57, 1048576
s_cbranch_scc1 L_end
s_cmp_eq_u32 s6, 1
s_waitcnt vmcnt(0)
ds_write_b128 v30, v[192:195]
v_cmp_ne_u32 s[52:53], s68, v252
v_max_u32 v240, v192, v193
v_max3_u32 v240, v240, v194, v195
v_cndmask_b32 v240, v240, -1, s[52:53]
v_cmp_eq_u32 vcc, -1, v240
s_cbranch_vccnz L_xq1_top
L_xj2:
s_waitcnt lgkmcnt(0)
s_barrier
s_mov_b32 s7, 1048576
L_q_reads:
ds_read_b128 v[72:75], v31 offset:0
ds_read_b128 v[76:79], v31 offset:64
ds_read_b128 v[80:83], v31 offset:128
ds_read_b128 v[84:87], v31 offset:192
s_add_u32 s58, s11, s7
s_waitcnt lgkmcnt(3)
v_mfma_f32_16x16x32_bf16 v[104:107], v[72:75], a[64:67], 0
ds_read_b64 v[90:91], v32
s_waitcnt lgkmcnt(3)
v_mfma_f32_16x16x32_bf16 v[104:107], v[76:79], a[68:71], v[104:107]
ds_read_b64_tr_b16 v[92:93], v33
s_waitcnt lgkmcnt(3)
v_mfma_f32_16x16x32_bf16 v[104:107], v[80:83], a[72:75], v[104:107]
ds_read_b64_tr_b16 v[94:95], v33 offset:128
s_waitcnt lgkmcnt(3)
v_mfma_f32_16x16x32_bf16 v[104:107], v[84:87], a[76:79], v[104:107]
ds_read_b64_tr_b16 v[96:97], v34
s_waitcnt lgkmcnt(3)
v_mfma_f32_16x16x32_bf16 v[104:107], v[88:91], a[78:81], v[104:107]
s_cmp_eq_u32 s7, 0
s_nop 6
v_add_f32 v104, v104, v105
v_add_f32 v106, v106, v107
v_add_f32 v104, v104, v106
v_mov_b32 v105, v104
s_nop 1
v_permlane32_swap_b32 v104, v105
v_add_f32 v104, v104, v105
v_mov_b32 v105, v104
s_cbranch_scc1 L_q0_pub
s_nop 0
v_permlane16_swap_b32 v104, v105
v_add_f32 v104, v104, v105
s_cmp_eq_u32 s9, 0
s_mov_b64 exec, 0xffff
s_cbranch_scc1 L_slow6
buffer_store_dword v104, v35, s[32:35], s58 offen
L_back7:
s_mov_b64 exec, -1
s_waitcnt lgkmcnt(0)
v_mfma_f32_16x16x16_bf16 v[116:119], v[4:5], v[92:93], 0
v_mfma_f32_16x16x16_bf16 v[120:123], v[4:5], v[94:95], 0
v_mfma_f32_16x16x16_bf16 v[124:127], v[6:7], v[96:97], 0
s_nop 6
v_add_f32 v242, v116, v120
v_mul_f32 v243, v116, v116
v_add_f32 v242, v242, v124
v_fmac_f32 v243, v120, v120
v_fmac_f32 v243, v124, v124
s_nop 0
s_nop 0
v_add_f32_dpp v242, v242, v242 quad_perm:[1,0,3,2] row_mask:0xf bank_mask:0xf
v_add_f32_dpp v243, v243, v243 quad_perm:[1,0,3,2] row_mask:0xf bank_mask:0xf
s_nop 0
v_add_f32_dpp v242, v242, v242 quad_perm:[2,3,0,1] row_mask:0xf bank_mask:0xf
v_add_f32_dpp v243, v243, v243 quad_perm:[2,3,0,1] row_mask:0xf bank_mask:0xf
s_nop 0
v_add_f32_dpp v242, v242, v242 row_half_mirror row_mask:0xf bank_mask:0xf
v_add_f32_dpp v243, v243, v243 row_half_mirror row_mask:0xf bank_mask:0xf
s_nop 0
v_add_f32_dpp v242, v242, v242 row_mirror row_mask:0xf bank_mask:0xf
v_add_f32_dpp v243, v243, v243 row_mirror row_mask:0xf bank_mask:0xf
s_cmp_eq_u32 s63, 0
s_cselect_b64 s[54:55], 1, 0
s_cmp_eq_u32 s9, 0
s_mov_b64 exec, s[54:55]
s_cbranch_scc1 L_slow8
buffer_store_dwordx2 v[242:243], v36, s[32:35], s58 offen
L_back9:
s_mov_b64 exec, -1
L_att_poll:
s_mov_b32 s57, 0
buffer_load_dwordx4 v[200:203], v37, s[32:35], s58 offen sc1
s_nop 7
s_nop 7
s_nop 7
.p2align 6
s_nop 0
s_nop 0
s_nop 0
s_nop 0
s_nop 0
s_nop 0
s_nop 0
s_nop 0
s_nop 0
s_nop 0
s_nop 0
L_poll10:
buffer_load_dwordx4 v[200:203], v37, s[32:35], s58 offen sc1
s_add_u32 s57, s57, 1
s_cmp_gt_u32 s57, 1048576
s_cbranch_scc1 L_end
s_waitcnt vmcnt(1)
v_max_u32 v240, v200, v201
v_max3_u32 v240, v240, v202, v203
v_cmp_eq_u32 vcc, -1, v240
s_cbranch_vccnz L_poll10
L_att_ok:
v_add_f32 v240, v200, v201
v_add_f32 v241, v202, v203
s_cmp_eq_u32 s7, 0
v_add_f32 v240, v240, v241
v_cvt_pk_bf16_f32 v241, v240, v240
ds_write_b16 v39, v241
v_lshlrev_b32 v242, 16, v241
v_sub_f32 v240, v240, v242
v_cvt_pk_bf16_f32 v240, v240, v240
ds_write_b16 v39, v240 offset:800
s_cbranch_scc1 L_att_nold
buffer_load_dwordx2 v[204:205], v38, s[32:35], s58 offen sc1
buffer_load_dwordx4 v[208:211], v47, s[32:35], s59 offen sc1
L_att_nold:
s_waitcnt lgkmcnt(0)
s_barrier
ds_read_b128 v[92:95], v40 offset:0
ds_read_b128 v[96:99], v40 offset:64
ds_read_b128 v[100:103], v40 offset:128
ds_read_b128 v[104:107], v40 offset:192
s_waitcnt lgkmcnt(3)
v_mfma_f32_16x16x32_bf16 v[108:111], v[92:95], v[128:131], 0
s_waitcnt lgkmcnt(2)
v_mfma_f32_16x16x32_bf16 v[108:111], v[96:99], v[132:135], v[108:111]
s_waitcnt lgkmcnt(1)
v_mfma_f32_16x16x32_bf16 v[108:111], v[100:103], v[136:139], v[108:111]
s_waitcnt lgkmcnt(0)
v_mfma_f32_16x16x32_bf16 v[108:111], v[104:107], v[140:143], v[108:111]
s_cbranch_scc1 L_att_nochk
s_waitcnt vmcnt(1)
v_max_u32 v243, v204, v205
v_cmp_eq_u32 vcc, -1, v243
s_cbranch_vccnz L_rc11
L_rcb13:
L_att_nochk:
v_mfma_f32_16x16x32_bf16 v[112:115], v[92:95], v[144:147], 0
v_add_f32_dpp v244, v204, v204 quad_perm:[1,0,3,2] row_mask:0xf bank_mask:0xf
v_add_f32_dpp v245, v205, v205 quad_perm:[1,0,3,2] row_mask:0xf bank_mask:0xf
v_mfma_f32_16x16x32_bf16 v[112:115], v[96:99], v[148:151], v[112:115]
v_add_f32_dpp v244, v244, v244 quad_perm:[2,3,0,1] row_mask:0xf bank_mask:0xf
v_add_f32_dpp v245, v245, v245 quad_perm:[2,3,0,1] row_mask:0xf bank_mask:0xf
v_mfma_f32_16x16x32_bf16 v[112:115], v[100:103], v[152:155], v[112:115]
v_add_f32_dpp v244, v244, v244 row_half_mirror row_mask:0xf bank_mask:0xf
v_add_f32_dpp v245, v245, v245 row_half_mirror row_mask:0xf bank_mask:0xf
v_mfma_f32_16x16x32_bf16 v[112:115], v[104:107], v[156:159], v[112:115]
v_add_f32_dpp v244, v244, v244 row_mirror row_mask:0xf bank_mask:0xf
v_add_f32_dpp v245, v245, v245 row_mirror row_mask:0xf bank_mask:0xf
v_mfma_f32_16x16x32_bf16 v[116:119], v[92:95], v[160:163], 0
v_mul_f32 v15, 1.736111111e-03, v244
v_mul_f32 v245, 1.736111111e-03, v245
v_mfma_f32_16x16x32_bf16 v[116:119], v[96:99], v[164:167], v[116:119]
v_fma_f32 v245, -v15, v15, v245
v_add_f32 v108, v108, v109
v_mfma_f32_16x16x32_bf16 v[116:119], v[100:103], v[168:171], v[116:119]
v_max_f32 v245, 0, v245
v_add_f32 v245, 0x3727c5ac, v245
v_mfma_f32_16x16x32_bf16 v[116:119], v[104:107], v[172:175], v[116:119]
v_rsq_f32 v14, v245
v_add_f32 v110, v110, v111
v_mfma_f32_16x16x32_bf16 v[120:123], v[92:95], v[176:179], 0
v_mul_f32 v14, 1.275174308e-01, v14
v_add_f32 v112, v112, v113
v_mfma_f32_16x16x32_bf16 v[120:123], v[96:99], v[180:183], v[120:123]
v_add_f32 v114, v114, v115
v_mul_f32 v15, v15, v14
v_mfma_f32_16x16x32_bf16 v[120:123], v[100:103], v[184:187], v[120:123]
v_mfma_f32_16x16x32_bf16 v[120:123], v[104:107], v[188:191], v[120:123]
v_add_f32 v116, v116, v117
v_add_f32 v118, v118, v119
v_cndmask_b32 v246, v108, v116, s[60:61]
v_cndmask_b32 v249, v110, v118, s[60:61]
v_mul_f32 v246, v246, v14
v_fma_f32 v246, -v15, v249, v246
s_nop 1
v_add_f32 v120, v120, v121
v_add_f32 v122, v122, v123
v_cndmask_b32 v247, v112, v120, s[60:61]
v_cndmask_b32 v249, v114, v122, s[60:61]
v_mul_f32 v247, v247, v14
v_fma_f32 v247, -v15, v249, v247
v_max_f32 v248, v246, v247
v_max_f32 v249, v246, v247
s_nop 1
v_permlane16_swap_b32 v248, v249
v_max_f32 v248, v248, v249
s_nop 1
v_max_f32_dpp v248, v248, v248 quad_perm:[1,0,3,2] row_mask:0xf bank_mask:0xf
s_nop 1
v_max_f32_dpp v248, v248, v248 quad_perm:[2,3,0,1] row_mask:0xf bank_mask:0xf
s_nop 1
v_max_f32_dpp v248, v248, v248 row_half_mirror row_mask:0xf bank_mask:0xf
s_nop 1
v_max_f32_dpp v248, v248, v248 row_mirror row_mask:0xf bank_mask:0xf
v_sub_f32 v246, v246, v248
v_sub_f32 v247, v247, v248
ds_write_b32 v42, v248
v_exp_f32 v246, v246
v_exp_f32 v247, v247
s_cmp_eq_u32 s7, 0
v_cvt_pk_bf16_f32 v249, v246, v247
ds_write_b32 v41, v249
v_lshlrev_b32 v246, 16, v249
v_and_b32 v247, 0xffff0000, v249
v_add_f32 v246, v246, v247
v_add_f32 v254, v246, 0
s_nop 1
v_permlane16_swap_b32 v246, v254
v_add_f32 v246, v246, v254
s_nop 1
v_add_f32_dpp v246, v246, v246 quad_perm:[1,0,3,2] row_mask:0xf bank_mask:0xf
s_cbranch_scc1 L_rdy
s_waitcnt lgkmcnt(0)
s_barrier
ds_read_b128 v[64:67], v43
ds_read_b32 v247, v44
ds_read_b128 v[68:71], v43 offset:64
ds_read_b128 v[72:75], v43 offset:128
ds_read_b128 v[76:79], v43 offset:192
s_waitcnt lgkmcnt(4)
v_mfma_f32_16x16x32_bf16 v[96:99], v[64:67], a[0:3], 0
ds_read_b128 v[80:83], v43 offset:256
v_mfma_f32_16x16x32_bf16 v[100:103], v[64:67], a[4:7], 0
ds_read_b128 v[84:87], v43 offset:320
s_waitcnt lgkmcnt(4)
v_mfma_f32_16x16x32_bf16 v[96:99], v[68:71], a[8:11], v[96:99]
ds_read_b128 v[88:91], v43 offset:384
v_add_f32_dpp v246, v246, v246 quad_perm:[2,3,0,1] row_mask:0xf bank_mask:0xf
v_mfma_f32_16x16x32_bf16 v[100:103], v[68:71], a[12:15], v[100:103]
ds_read_b128 v[92:95], v43 offset:448
v_max_f32_dpp v249, v247, v247 quad_perm:[1,0,3,2] row_mask:0xf bank_mask:0xf
s_waitcnt lgkmcnt(4)
v_mfma_f32_16x16x32_bf16 v[104:107], v[72:75], a[16:19], 0
v_add_f32_dpp v246, v246, v246 row_half_mirror row_mask:0xf bank_mask:0xf
v_max_f32_dpp v249, v249, v249 quad_perm:[2,3,0,1] row_mask:0xf bank_mask:0xf
v_mfma_f32_16x16x32_bf16 v[108:111], v[72:75], a[20:23], 0
v_add_f32_dpp v246, v246, v246 row_mirror row_mask:0xf bank_mask:0xf
v_sub_f32 v247, v247, v249
v_mfma_f32_16x16x32_bf16 v[104:107], v[76:79], a[24:27], v[104:107]
v_sub_f32 v248, v248, v249
v_exp_f32 v247, v247
v_mfma_f32_16x16x32_bf16 v[108:111], v[76:79], a[28:31], v[108:111]
v_exp_f32 v248, v248
s_nop 0
s_waitcnt lgkmcnt(2)
v_mfma_f32_16x16x32_bf16 v[112:115], v[80:83], a[32:35], 0
v_mul_f32 v246, v246, v248
v_cndmask_b32 v246, v246, v249, s[72:73]
v_mfma_f32_16x16x32_bf16 v[116:119], v[80:83], a[36:39], 0
v_mul_f32_dpp v254, v247, v96 row_newbcast:0 row_mask:0xf bank_mask:0xf
v_mul_f32_dpp v248, v247, v100 row_newbcast:0 row_mask:0xf bank_mask:0xf
v_mfma_f32_16x16x32_bf16 v[112:115], v[84:87], a[40:43], v[112:115]
v_fmac_f32_dpp v254, v247, v104 row_newbcast:1 row_mask:0xf bank_mask:0xf
v_fmac_f32_dpp v248, v247, v108 row_newbcast:1 row_mask:0xf bank_mask:0xf
v_mfma_f32_16x16x32_bf16 v[116:119], v[84:87], a[44:47], v[116:119]
s_waitcnt lgkmcnt(0)
v_mfma_f32_16x16x32_bf16 v[120:123], v[88:91], a[48:51], 0
v_mfma_f32_16x16x32_bf16 v[124:127], v[88:91], a[52:55], 0
v_mfma_f32_16x16x32_bf16 v[120:123], v[92:95], a[56:59], v[120:123]
v_mfma_f32_16x16x32_bf16 v[124:127], v[92:95], a[60:63], v[124:127]
v_mov_b32 v88, 0
v_mov_b32 v89, 0
v_fmac_f32_dpp v254, v247, v112 row_newbcast:2 row_mask:0xf bank_mask:0xf
v_fmac_f32_dpp v248, v247, v116 row_newbcast:2 row_mask:0xf bank_mask:0xf
s_nop 2
v_fmac_f32_dpp v254, v247, v120 row_newbcast:3 row_mask:0xf bank_mask:0xf
v_fmac_f32_dpp v248, v247, v124 row_newbcast:3 row_mask:0xf bank_mask:0xf
v_cvt_pk_bf16_f32 v254, v254, v248
v_cndmask_b32 v254, v254, v246, s[60:61]
s_cmp_eq_u32 s9, 0
s_mov_b64 exec, s[48:49]
s_cbranch_scc1 L_slow14
buffer_store_dword v254, v45, s[32:35], s58 offen
L_back15:
s_mov_b64 exec, -1
s_cmp_lg_u32 s8, 0
s_cbranch_scc1 L_roleBF
s_waitcnt vmcnt(1)
v_max_u32 v240, v208, v209
v_max3_u32 v240, v240, v210, v211
v_cmp_eq_u32 vcc, -1, v240
s_cbranch_vccnz L_rc21
L_rcb23:
v_mfma_f32_16x16x32_bf16 v[20:23], v[16:19], v[208:211], 0
L_wo_go:
s_mov_b32 s57, 0
buffer_load_dwordx4 v[212:215], v48, s[32:35], s58 offen sc1
buffer_load_dwordx4 v[216:219], v48, s[32:35], s58 offen offset:1024 sc1
buffer_load_dwordx4 v[220:223], v49, s[32:35], s58 offen sc1
s_nop 7
s_nop 7
s_nop 7
.p2align 6
s_nop 0
s_nop 0
s_nop 0
s_nop 0
s_nop 0
s_nop 0
s_nop 0
s_nop 0
s_nop 0
s_nop 0
s_nop 0
L_poll24:
buffer_load_dwordx4 v[212:215], v48, s[32:35], s58 offen sc1
buffer_load_dwordx4 v[216:219], v48, s[32:35], s58 offen offset:1024 sc1
buffer_load_dwordx4 v[220:223], v49, s[32:35], s58 offen sc1
s_add_u32 s57, s57, 1
s_cmp_gt_u32 s57, 1048576
s_cbranch_scc1 L_end
s_waitcnt vmcnt(3)
v_max_u32 v240, v212, v213
v_max3_u32 v240, v240, v214, v215
ds_write_b128 v50, v[212:215]
v_max3_u32 v240, v240, v216, v217
v_max3_u32 v240, v240, v218, v219
ds_write_b128 v50, v[216:219] offset:1088
v_max3_u32 v240, v240, v220, v221
v_max3_u32 v240, v240, v222, v223
v_cmp_eq_u32 vcc, -1, v240
s_cbranch_vccnz L_poll24
v_cndmask_b32 v241, v220, v221, s[60:61]
v_cndmask_b32 v242, v220, v221, s[60:61]
v_add_f32 v240, v220, v221
v_add_f32 v243, v222, v223
v_permlane32_swap_b32 v241, v242
v_add_f32 v240, v240, v243
s_nop 0
v_max_f32_dpp v243, v242, v242 quad_perm:[1,0,3,2] row_mask:0xf bank_mask:0xf
s_nop 1
v_max_f32_dpp v243, v243, v243 quad_perm:[2,3,0,1] row_mask:0xf bank_mask:0xf
s_nop 1
v_max_f32_dpp v243, v243, v243 row_half_mirror row_mask:0xf bank_mask:0xf
s_nop 1
v_max_f32_dpp v243, v243, v243 row_mirror row_mask:0xf bank_mask:0xf
v_sub_f32 v242, v242, v243
v_exp_f32 v242, v242
s_waitcnt lgkmcnt(0)
s_barrier
ds_read_b128 v[92:95], v51 offset:0
ds_read_b128 v[96:99], v51 offset:64
ds_read_b128 v[100:103], v51 offset:128
ds_read_b128 v[104:107], v51 offset:192
v_mul_f32 v240, v240, v242
s_nop 1
v_add_f32_dpp v240, v240, v240 quad_perm:[1,0,3,2] row_mask:0xf bank_mask:0xf
s_waitcnt lgkmcnt(3)
v_mfma_f32_16x16x32_bf16 v[248:251], a[84:87], v[92:95], 0
v_add_f32_dpp v240, v240, v240 quad_perm:[2,3,0,1] row_mask:0xf bank_mask:0xf
ds_read_b128 v[108:111], v51 offset:256
s_waitcnt lgkmcnt(3)
v_mfma_f32_16x16x32_bf16 v[248:251], a[88:91], v[96:99], v[248:251]
v_add_f32_dpp v240, v240, v240 row_half_mirror row_mask:0xf bank_mask:0xf
ds_read_b128 v[112:115], v51 offset:320
s_waitcnt lgkmcnt(3)
v_mfma_f32_16x16x32_bf16 v[248:251], a[92:95], v[100:103], v[248:251]
v_add_f32_dpp v240, v240, v240 row_mirror row_mask:0xf bank_mask:0xf
ds_read_b128 v[116:119], v51 offset:384
s_waitcnt lgkmcnt(3)
v_mfma_f32_16x16x32_bf16 v[248:251], a[96:99], v[104:107], v[248:251]
v_rcp_f32 v240, v240
ds_read_b128 v[120:123], v51 offset:448
s_waitcnt lgkmcnt(3)
v_mfma_f32_16x16x32_bf16 v[252:255], a[100:103], v[108:111], 0
v_mul_f32 v242, v242, v240
v_mov_b32 v243, v242
s_waitcnt lgkmcnt(2)
v_mfma_f32_16x16x32_bf16 v[252:255], a[104:107], v[112:115], v[252:255]
v_permlane32_swap_b32 v242, v243
v_mov_b32 v241, v242
s_waitcnt lgkmcnt(1)
v_mfma_f32_16x16x32_bf16 v[252:255], a[108:111], v[116:119], v[252:255]
s_nop 0
v_permlane16_swap_b32 v242, v241
s_waitcnt lgkmcnt(0)
v_mfma_f32_16x16x32_bf16 v[252:255], a[112:115], v[120:123], v[252:255]
v_fma_f32 v244, v242, v248, v20
v_fma_f32 v245, v242, v249, v21
v_fma_f32 v246, v242, v250, v22
v_fma_f32 v247, v242, v251, v23
s_nop 3
v_fmac_f32 v244, v241, v252
v_fmac_f32 v245, v241, v253
v_fmac_f32 v246, v241, v254
v_fmac_f32 v247, v241, v255
v_add_f32_dpp v244, v244, v244 quad_perm:[1,0,3,2] row_mask:0xf bank_mask:0xf
v_add_f32_dpp v245, v245, v245 quad_perm:[1,0,3,2] row_mask:0xf bank_mask:0xf
v_add_f32_dpp v246, v246, v246 quad_perm:[1,0,3,2] row_mask:0xf bank_mask:0xf
v_add_f32_dpp v247, v247, v247 quad_perm:[1,0,3,2] row_mask:0xf bank_mask:0xf
v_add_f32_dpp v244, v244, v244 quad_perm:[2,3,0,1] row_mask:0xf bank_mask:0xf
v_add_f32_dpp v245, v245, v245 quad_perm:[2,3,0,1] row_mask:0xf bank_mask:0xf
v_add_f32_dpp v246, v246, v246 quad_perm:[2,3,0,1] row_mask:0xf bank_mask:0xf
v_add_f32_dpp v247, v247, v247 quad_perm:[2,3,0,1] row_mask:0xf bank_mask:0xf
v_add_f32_dpp v244, v244, v244 row_half_mirror row_mask:0xf bank_mask:0xf
v_add_f32_dpp v245, v245, v245 row_half_mirror row_mask:0xf bank_mask:0xf
v_add_f32_dpp v246, v246, v246 row_half_mirror row_mask:0xf bank_mask:0xf
v_add_f32_dpp v247, v247, v247 row_half_mirror row_mask:0xf bank_mask:0xf
v_add_f32_dpp v244, v244, v244 row_mirror row_mask:0xf bank_mask:0xf
v_add_f32_dpp v245, v245, v245 row_mirror row_mask:0xf bank_mask:0xf
v_add_f32_dpp v246, v246, v246 row_mirror row_mask:0xf bank_mask:0xf
v_add_f32_dpp v247, v247, v247 row_mirror row_mask:0xf bank_mask:0xf
v_cvt_pk_bf16_f32 v244, v244, v245
v_cvt_pk_bf16_f32 v245, v246, v247
ds_write_b64 v63, v[244:245]
s_add_u32 s52, s7, 0
s_cmp_eq_u32 s9, 0
s_mov_b64 exec, s[70:71]
s_cbranch_scc1 L_slow26
buffer_store_dword v1, v53, s[32:35], s58 offen offset:0
L_back27:
s_mov_b64 exec, -1
s_cmp_lg_u32 s6, 0
s_waitcnt lgkmcnt(0)
s_barrier
s_cbranch_scc1 L_xp25
ds_read_b128 v[244:247], v13
s_mov_b64 exec, 0xffff
s_waitcnt lgkmcnt(0)
buffer_store_dwordx4 v[244:247], v52, s[32:35], s52 offen sc1
s_mov_b64 exec, -1
L_xp25:
s_cmp_eq_u32 s7, 0
s_cbranch_scc1 L_w2_first
s_add_u32 s59, s7, s10
s_mov_b32 s57, 0
buffer_load_dwordx4 v[224:227], v54, s[32:35], s58 offen sc1
buffer_load_dwordx4 v[228:231], v55, s[32:35], s58 offen sc1
s_nop 7
s_nop 7
s_nop 7
.p2align 6
s_nop 0
s_nop 0
s_nop 0
s_nop 0
s_nop 0
s_nop 0
s_nop 0
s_nop 0
s_nop 0
s_nop 0
s_nop 0
L_poll28:
buffer_load_dwordx4 v[224:227], v54, s[32:35], s58 offen sc1
buffer_load_dwordx4 v[228:231], v55, s[32:35], s58 offen sc1
s_add_u32 s57, s57, 1
s_cmp_gt_u32 s57, 1048576
s_cbranch_scc1 L_end
s_waitcnt vmcnt(2)
v_max_u32 v240, v224, v225
v_max3_u32 v240, v240, v226, v227
v_max3_u32 v240, v240, v228, v229
v_max3_u32 v240, v240, v230, v231
v_cmp_eq_u32 vcc, -1, v240
s_cbranch_vccnz L_poll28
L_w2_ok:
v_add_f32 v248, v228, v230
v_add_f32 v249, v229, v231
buffer_load_dwordx4 v[236:239], v47, s[32:35], s59 offen sc1
v_add_f32 v240, v224, v225
v_add_f32_dpp v250, v248, v248 quad_perm:[1,0,3,2] row_mask:0xf bank_mask:0xf
v_add_f32_dpp v251, v249, v249 quad_perm:[1,0,3,2] row_mask:0xf bank_mask:0xf
v_add_f32 v241, v226, v227
v_add_f32_dpp v250, v250, v250 quad_perm:[2,3,0,1] row_mask:0xf bank_mask:0xf
v_add_f32_dpp v251, v251, v251 quad_perm:[2,3,0,1] row_mask:0xf bank_mask:0xf
v_add_f32 v244, v248, v249
v_add_f32_dpp v250, v250, v250 row_half_mirror row_mask:0xf bank_mask:0xf
v_add_f32_dpp v251, v251, v251 row_half_mirror row_mask:0xf bank_mask:0xf
v_add_f32 v240, v240, v241
v_mul_f32_dpp v250, v250, v59 row_newbcast:15 row_mask:0xf bank_mask:0xf
v_mul_f32_dpp v251, v251, v59 row_newbcast:15 row_mask:0xf bank_mask:0xf
v_fma_f32 v251, -v250, v250, v251
v_fma_f32 v240, -v250, v26, v240
v_max_f32 v251, 0, v251
v_add_f32 v251, 0x3727c5ac, v251
v_rsq_f32 v251, v251
v_fma_f32 v244, -v250, v27, v244
s_mov_b32 s52, -1.442695041e+00
v_fma_f32 v240, v240, v251, v24
v_fma_f32 v244, v244, v251, v25
v_mul_f32 v241, s52, abs(v240)
v_mul_f32 v245, s52, abs(v244)
v_exp_f32 v241, v241
v_exp_f32 v245, v245
v_cmp_le_f32 vcc, 0, v240
v_cmp_le_f32 s[54:55], 0, v244
v_fma_f32 v242, v241, 2.0, 1.0
v_add_f32 v243, 2.0, v241
v_fma_f32 v246, v245, 2.0, 1.0
v_add_f32 v247, 2.0, v245
v_mul_f32 v243, v243, v241
v_mul_f32 v248, v241, v241
v_mul_f32 v247, v247, v245
v_mul_f32 v249, v245, v245
v_cndmask_b32 v242, v243, v242, vcc
v_cndmask_b32 v246, v247, v246, s[54:55]
v_cndmask_b32 v248, 1.0, v248, vcc
v_cndmask_b32 v249, 1.0, v249, s[54:55]
v_fma_f32 v248, v248, 2.0, v242
v_fma_f32 v249, v249, 2.0, v246
v_rcp_f32 v248, v248
v_rcp_f32 v249, v249
v_mul_f32 v240, v240, v242
v_mul_f32 v244, v244, v246
v_mul_f32 v240, v240, v248
v_mul_f32 v244, v244, v249
v_cvt_pk_bf16_f32 v240, v240, v244
ds_write_b16 v56, v240
ds_write_b16_d16_hi v57, v240
s_waitcnt lgkmcnt(0)
s_barrier
ds_read_b128 v[92:95], v58 offset:0
ds_read_b128 v[96:99], v58 offset:64
ds_read_b128 v[100:103], v58 offset:128
ds_read_b128 v[104:107], v58 offset:192
s_waitcnt vmcnt(0)
v_max_u32 v241, v236, v237
v_max3_u32 v241, v241, v238, v239
v_cmp_eq_u32 vcc, -1, v241
s_cbranch_vccnz L_rc29
L_rcb31:
v_mfma_f32_16x16x32_bf16 v[20:23], v[16:19], v[236:239], 0
s_waitcnt lgkmcnt(3)
v_mfma_f32_16x16x32_bf16 v[244:247], a[116:119], v[92:95], 0
ds_read_b128 v[108:111], v58 offset:256
s_waitcnt lgkmcnt(3)
v_mfma_f32_16x16x32_bf16 v[244:247], a[120:123], v[96:99], v[244:247]
ds_read_b128 v[112:115], v58 offset:320
s_waitcnt lgkmcnt(3)
v_mfma_f32_16x16x32_bf16 v[244:247], a[124:127], v[100:103], v[244:247]
ds_read_b128 v[116:119], v58 offset:384
s_waitcnt lgkmcnt(3)
v_mfma_f32_16x16x32_bf16 v[244:247], a[128:131], v[104:107], v[244:247]
ds_read_b128 v[120:123], v58 offset:448
v_add_f32_dpp v20, v20, v20 quad_perm:[1,0,3,2] row_mask:0xf bank_mask:0xf
s_waitcnt lgkmcnt(3)
v_mfma_f32_16x16x32_bf16 v[244:247], a[132:135], v[108:111], v[244:247]
ds_read_b128 v[124:127], v58 offset:512
v_add_f32_dpp v21, v21, v21 quad_perm:[1,0,3,2] row_mask:0xf bank_mask:0xf
s_waitcnt lgkmcnt(3)
v_mfma_f32_16x16x32_bf16 v[244:247], a[136:139], v[112:115], v[244:247]
v_add_f32_dpp v22, v22, v22 quad_perm:[1,0,3,2] row_mask:0xf bank_mask:0xf
v_add_f32_dpp v23, v23, v23 quad_perm:[1,0,3,2] row_mask:0xf bank_mask:0xf
s_waitcnt lgkmcnt(2)
v_mfma_f32_16x16x32_bf16 v[244:247], a[140:143], v[116:119], v[244:247]
v_add_f32_dpp v20, v20, v20 quad_perm:[2,3,0,1] row_mask:0xf bank_mask:0xf
v_add_f32_dpp v21, v21, v21 quad_perm:[2,3,0,1] row_mask:0xf bank_mask:0xf
s_waitcnt lgkmcnt(1)
v_mfma_f32_16x16x32_bf16 v[244:247], a[144:147], v[120:123], v[244:247]
v_add_f32_dpp v22, v22, v22 quad_perm:[2,3,0,1] row_mask:0xf bank_mask:0xf
v_add_f32_dpp v23, v23, v23 quad_perm:[2,3,0,1] row_mask:0xf bank_mask:0xf
s_waitcnt lgkmcnt(0)
v_mfma_f32_16x16x32_bf16 v[244:247], a[148:151], v[124:127], v[244:247]
v_add_f32_dpp v20, v20, v20 row_half_mirror row_mask:0xf bank_mask:0xf
v_add_f32_dpp v21, v21, v21 row_half_mirror row_mask:0xf bank_mask:0xf
v_add_f32_dpp v22, v22, v22 row_half_mirror row_mask:0xf bank_mask:0xf
v_add_f32_dpp v23, v23, v23 row_half_mirror row_mask:0xf bank_mask:0xf
v_add_f32_dpp v20, v20, v20 row_mirror row_mask:0xf bank_mask:0xf
v_add_f32_dpp v21, v21, v21 row_mirror row_mask:0xf bank_mask:0xf
v_add_f32_dpp v22, v22, v22 row_mirror row_mask:0xf bank_mask:0xf
v_add_f32_dpp v23, v23, v23 row_mirror row_mask:0xf bank_mask:0xf
v_add_f32 v244, v244, v20
v_add_f32 v245, v245, v21
v_add_f32 v246, v246, v22
v_add_f32 v247, v247, v23
v_cvt_pk_bf16_f32 v244, v244, v245
v_cvt_pk_bf16_f32 v245, v246, v247
ds_write_b64 v63, v[244:245]
s_add_u32 s52, s7, 65536
s_cmp_eq_u32 s9, 0
s_mov_b64 exec, s[70:71]
s_cbranch_scc1 L_slow33
buffer_store_dword v1, v53, s[32:35], s58 offen offset:128
L_back34:
s_mov_b64 exec, -1
s_cmp_lg_u32 s6, 0
s_waitcnt lgkmcnt(0)
s_barrier
s_cbranch_scc1 L_xp32
ds_read_b128 v[244:247], v13
s_mov_b64 exec, 0xffff
s_waitcnt lgkmcnt(0)
buffer_store_dwordx4 v[244:247], v52, s[32:35], s52 offen sc1
s_mov_b64 exec, -1
L_xp32:
s_cmp_eq_u32 s7, 0
s_cbranch_scc1 L_a_first
s_branch L_done
L_walk1_2:
s_branch L_walk1_3
L_roleBF:
s_cmp_lg_u32 s8, 1
s_cbranch_scc1 L_done
L_w1_go:
s_add_u32 s59, s7, s10
s_cmp_lg_u32 s6, 0
s_cbranch_scc1 L_xo35
s_barrier
s_mov_b32 s57, 0
L_poll37:
buffer_load_dwordx4 v[192:195], v48, s[32:35], s59 offen sc1
buffer_load_dwordx4 v[196:199], v49, s[32:35], s59 offen sc1
s_add_u32 s57, s57, 1
s_cmp_gt_u32 s57, 1048576
s_cbranch_scc1 L_end
s_cmp_lg_u32 s98, 0
s_cbranch_scc1 L_hk38
s_waitcnt vmcnt(0)
L_ha39:
ds_write_b128 v30, v[192:195]
s_mov_b32 exec_hi, 0
ds_write_b128 v30, v[196:199] offset:4096
s_mov_b32 exec_hi, -1
v_max_u32 v240, v192, v193
v_max3_u32 v240, v240, v194, v195
v_max3_u32 v240, v240, v196, v197
v_max3_u32 v240, v240, v198, v199
v_cmp_eq_u32 vcc, -1, v240
s_cbranch_vccnz L_poll37
s_branch L_xj36
L_walk1_3:
s_branch L_walk1_4
L_xo35:
s_cmp_lg_u32 s6, 3
s_cbranch_scc1 L_hs42
s_mov_b32 s57, 0
buffer_load_dword v232, v46, s[32:35], s58 offen offset:0 sc1
s_nop 7
s_nop 7
s_nop 7
.p2align 6
s_nop 0
s_nop 0
s_nop 0
s_nop 0
s_nop 0
s_nop 0
s_nop 0
s_nop 0
s_nop 0
s_nop 0
s_nop 0
L_poll43:
buffer_load_dword v232, v46, s[32:35], s58 offen offset:0 sc1
s_add_u32 s57, s57, 1
s_cmp_gt_u32 s57, 1048576
s_cbranch_scc1 L_end
s_waitcnt vmcnt(1)
v_cmp_eq_u32 vcc, -1, v232
s_cbranch_vccnz L_poll43
s_cmp_lt_u32 s57, 2
s_cbranch_scc1 L_hs42
s_nop 7
s_nop 7
s_nop 7
s_nop 7
s_nop 7
s_nop 7
s_nop 7
s_nop 7
L_hs42:
s_barrier
s_mov_b32 s57, 0
L_poll44:
buffer_load_dwordx4 v[192:195], v48, s[32:35], s59 offen sc1
s_add_u32 s57, s57, 1
s_cmp_gt_u32 s57, 1048576
s_cbranch_scc1 L_end
s_cmp_lg_u32 s98, 0
s_cbranch_scc1 L_hk45
s_waitcnt vmcnt(0)
L_ha46:
ds_write_b128 v30, v[192:195]
v_max_u32 v240, v192, v193
v_max3_u32 v240, v240, v194, v195
v_cmp_eq_u32 vcc, -1, v240
s_cbranch_vccnz L_poll44
L_xj36:
s_waitcnt lgkmcnt(0)
s_barrier
ds_read_b128 v[72:75], v31 offset:0
ds_read_b64_tr_b16 v[92:93], v33
ds_read_b64_tr_b16 v[94:95], v33 offset:128
ds_read_b64_tr_b16 v[96:97], v34
s_waitcnt lgkmcnt(3)
v_mfma_f32_16x16x32_bf16 v[104:107], v[72:75], a[84:87], 0
ds_read_b128 v[76:79], v31 offset:64
v_mfma_f32_16x16x32_bf16 v[108:111], v[72:75], a[102:105], 0
ds_read_b128 v[80:83], v31 offset:128
v_mfma_f32_16x16x32_bf16 v[112:115], v[72:75], a[120:123], 0
ds_read_b128 v[84:87], v31 offset:192
s_waitcnt lgkmcnt(5)
v_mfma_f32_16x16x16_bf16 v[116:119], v[4:5], v[92:93], 0
ds_read_b64 v[90:91], v32
s_waitcnt lgkmcnt(5)
v_mfma_f32_16x16x16_bf16 v[120:123], v[4:5], v[94:95], 0
s_waitcnt lgkmcnt(4)
v_mfma_f32_16x16x16_bf16 v[124:127], v[6:7], v[96:97], 0
s_waitcnt lgkmcnt(3)
v_mfma_f32_16x16x32_bf16 v[104:107], v[76:79], a[88:91], v[104:107]
v_mfma_f32_16x16x32_bf16 v[108:111], v[76:79], a[106:109], v[108:111]
v_mfma_f32_16x16x32_bf16 v[112:115], v[76:79], a[124:127], v[112:115]
s_waitcnt lgkmcnt(2)
v_mfma_f32_16x16x32_bf16 v[104:107], v[80:83], a[92:95], v[104:107]
v_add_f32 v242, v116, v120
v_mul_f32 v243, v116, v116
v_mfma_f32_16x16x32_bf16 v[108:111], v[80:83], a[110:113], v[108:111]
v_add_f32 v242, v242, v124
v_fmac_f32 v243, v120, v120
v_mfma_f32_16x16x32_bf16 v[112:115], v[80:83], a[128:131], v[112:115]
v_fmac_f32 v243, v124, v124
s_nop 0
s_waitcnt lgkmcnt(1)
v_mfma_f32_16x16x32_bf16 v[104:107], v[84:87], a[96:99], v[104:107]
s_nop 0
v_add_f32_dpp v242, v242, v242 quad_perm:[1,0,3,2] row_mask:0xf bank_mask:0xf
v_mfma_f32_16x16x32_bf16 v[108:111], v[84:87], a[114:117], v[108:111]
v_add_f32_dpp v243, v243, v243 quad_perm:[1,0,3,2] row_mask:0xf bank_mask:0xf
s_nop 0
v_mfma_f32_16x16x32_bf16 v[112:115], v[84:87], a[132:135], v[112:115]
v_add_f32_dpp v242, v242, v242 quad_perm:[2,3,0,1] row_mask:0xf bank_mask:0xf
v_add_f32_dpp v243, v243, v243 quad_perm:[2,3,0,1] row_mask:0xf bank_mask:0xf
s_waitcnt lgkmcnt(0)
v_mfma_f32_16x16x32_bf16 v[104:107], v[88:91], a[98:101], v[104:107]
s_nop 0
v_add_f32_dpp v242, v242, v242 row_half_mirror row_mask:0xf bank_mask:0xf
v_mfma_f32_16x16x32_bf16 v[108:111], v[88:91], a[116:119], v[108:111]
v_add_f32_dpp v243, v243, v243 row_half_mirror row_mask:0xf bank_mask:0xf
s_nop 0
v_mfma_f32_16x16x32_bf16 v[112:115], v[88:91], a[134:137], v[112:115]
v_add_f32_dpp v242, v242, v242 row_mirror row_mask:0xf bank_mask:0xf
v_add_f32_dpp v243, v243, v243 row_mirror row_mask:0xf bank_mask:0xf
v_cndmask_b32 v242, v242, v243, s[72:73]
s_nop 3
v_add_f32 v104, v104, v105
v_add_f32 v106, v106, v107
v_add_f32 v108, v108, v109
v_add_f32 v110, v110, v111
v_add_f32 v112, v112, v113
v_add_f32 v114, v114, v115
v_add_f32 v104, v104, v106
v_add_f32 v108, v108, v110
v_add_f32 v113, v112, v114
v_add_f32 v112, v112, v114
v_permlane32_swap_b32 v104, v108
v_add_f32 v104, v104, v108
v_permlane32_swap_b32 v112, v113
v_add_f32 v112, v112, v113
s_nop 1
v_permlane16_swap_b32 v104, v112
v_add_f32 v104, v104, v112
v_cndmask_b32 v104, v104, v242, s[90:91]
s_cmp_eq_u32 s9, 0
s_mov_b64 exec, s[50:51]
s_cbranch_scc1 L_slow49
buffer_store_dword v104, v50, s[32:35], s58 offen
L_back50:
s_mov_b64 exec, -1
s_cmp_eq_u32 s7, 0
s_cbranch_scc1 L_bf_first
s_sub_u32 s97, s5, 18
s_lshl_b32 s52, s4, 4
s_add_u32 s52, s52, s97
s_cmp_ge_u32 s52, 9
s_cbranch_scc1 L_done
s_and_b32 s52, s6, 1
s_lshl_b32 s52, s52, 1
v_lshrrev_b32 v64, 3, v2
v_add_u32 v64, s52, v64
v_and_b32 v65, 1, v2
v_lshlrev_b32 v65, 4, v65
v_mov_b32 v66, 0x3f80
v_lshlrev_b32 v65, v65, v66
v_cmp_eq_u32 vcc, v64, v3
v_bfe_u32 v66, v2, 1, 2
v_lshrrev_b32 v47, 2, v2
v_cndmask_b32 v65, 0, v65, vcc
v_cmp_eq_u32 vcc, 0, v66
s_nop 1
v_cndmask_b32 v16, 0, v65, vcc
v_cmp_eq_u32 vcc, 1, v66
s_nop 1
v_cndmask_b32 v17, 0, v65, vcc
v_cmp_eq_u32 vcc, 2, v66
s_nop 1
v_cndmask_b32 v18, 0, v65, vcc
v_cmp_eq_u32 vcc, 3, v66
s_nop 1
v_cndmask_b32 v19, 0, v65, vcc
v_lshlrev_b32 v47, 14, v47
v_and_b32 v64, 3, v2
v_lshl_add_u32 v47, v64, 11, v47
v_lshl_add_u32 v47, v3, 4, v47
s_lshl_b32 s52, s97, 7
s_lshr_b32 s53, s6, 1
s_lshl_b32 s53, s53, 6
s_add_u32 s52, s52, s53
v_add_u32 v47, s52, v47
s_lshl_b32 s52, s97, 7
s_lshl_b32 s53, s6, 5
s_add_u32 s52, s52, s53
v_lshl_add_u32 v52, v3, 3, s52
s_add_u32 s59, s10, 1114112
s_mov_b32 s54, 0x00010001
s_mov_b32 s55, 0x00010001
s_mov_b64 exec, s[54:55]
buffer_store_dwordx2 v[88:89], v52, s[44:47], 0 offen
s_mov_b64 exec, -1
s_cmp_lg_u32 s6, 3
s_cbranch_scc1 L_hs51
s_mov_b32 s57, 0
buffer_load_dword v232, v46, s[32:35], s58 offen offset:128 sc1
s_nop 7
s_nop 7
s_nop 7
.p2align 6
s_nop 0
s_nop 0
s_nop 0
s_nop 0
s_nop 0
s_nop 0
s_nop 0
L_poll52:
buffer_load_dword v232, v46, s[32:35], s58 offen offset:128 sc1
s_add_u32 s57, s57, 1
s_cmp_gt_u32 s57, 1048576
s_cbranch_scc1 L_end
s_waitcnt vmcnt(1)
v_cmp_eq_u32 vcc, -1, v232
s_cbranch_vccnz L_poll52
s_cmp_lt_u32 s57, 2
s_cbranch_scc1 L_hs51
s_nop 7
s_nop 7
s_nop 7
s_nop 7
s_nop 7
s_nop 7
s_nop 7
s_nop 7
L_hs51:
s_barrier
s_mov_b32 s57, 0
L_poll53:
buffer_load_dwordx4 v[208:211], v47, s[32:35], s59 offen sc1
s_add_u32 s57, s57, 1
s_cmp_gt_u32 s57, 1048576
s_cbranch_scc1 L_end
s_waitcnt vmcnt(0)
v_mfma_f32_16x16x32_bf16 v[20:23], v[16:19], v[208:211], 0
v_max_u32 v240, v208, v209
v_max3_u32 v240, v240, v210, v211
v_cmp_eq_u32 vcc, -1, v240
s_cbranch_vccnz L_poll53
s_nop 3
v_add_f32_dpp v20, v20, v20 quad_perm:[1,0,3,2] row_mask:0xf bank_mask:0xf
v_add_f32_dpp v21, v21, v21 quad_perm:[1,0,3,2] row_mask:0xf bank_mask:0xf
v_add_f32_dpp v22, v22, v22 quad_perm:[1,0,3,2] row_mask:0xf bank_mask:0xf
v_add_f32_dpp v23, v23, v23 quad_perm:[1,0,3,2] row_mask:0xf bank_mask:0xf
v_add_f32_dpp v20, v20, v20 quad_perm:[2,3,0,1] row_mask:0xf bank_mask:0xf
v_add_f32_dpp v21, v21, v21 quad_perm:[2,3,0,1] row_mask:0xf bank_mask:0xf
v_add_f32_dpp v22, v22, v22 quad_perm:[2,3,0,1] row_mask:0xf bank_mask:0xf
v_add_f32_dpp v23, v23, v23 quad_perm:[2,3,0,1] row_mask:0xf bank_mask:0xf
v_add_f32_dpp v20, v20, v20 row_half_mirror row_mask:0xf bank_mask:0xf
v_add_f32_dpp v21, v21, v21 row_half_mirror row_mask:0xf bank_mask:0xf
v_add_f32_dpp v22, v22, v22 row_half_mirror row_mask:0xf bank_mask:0xf
v_add_f32_dpp v23, v23, v23 row_half_mirror row_mask:0xf bank_mask:0xf
v_add_f32_dpp v20, v20, v20 row_mirror row_mask:0xf bank_mask:0xf
v_add_f32_dpp v21, v21, v21 row_mirror row_mask:0xf bank_mask:0xf
v_add_f32_dpp v22, v22, v22 row_mirror row_mask:0xf bank_mask:0xf
v_add_f32_dpp v23, v23, v23 row_mirror row_mask:0xf bank_mask:0xf
v_cvt_pk_bf16_f32 v20, v20, v21
s_mov_b64 exec, s[54:55]
v_cvt_pk_bf16_f32 v21, v22, v23
buffer_store_dwordx2 v[20:21], v52, s[44:47], 0 offen
s_mov_b64 exec, -1
L_done:
L_end:
s_endpgm
L_slow6:
buffer_store_dword v104, v35, s[32:35], s58 offen sc1
s_branch L_back7
L_slow8:
buffer_store_dwordx2 v[242:243], v36, s[32:35], s58 offen sc1
s_branch L_back9
L_walk0_0:
s_branch L_walk0_1
L_q0_pub:
s_nop 0
v_permlane16_swap_b32 v104, v105
v_add_f32 v60, v104, v105
v_mov_b32 v61, s68
v_lshlrev_b32 v62, 1, v35
s_mov_b64 exec, 0xffff
buffer_store_dwordx2 v[60:61], v62, s[32:35], s69 offen
s_mov_b64 exec, -1
s_xor_b32 m0, s66, 32768
s_nop 0
buffer_load_dwordx4 v10, s[12:15], m0 offen nt lds
s_xor_b32 m0, s66, 36864
s_nop 0
buffer_load_dwordx4 v10, s[12:15], m0 offen nt lds
s_xor_b32 m0, s66, 40960
s_nop 0
buffer_load_dwordx4 v10, s[12:15], m0 offen nt lds
s_xor_b32 m0, s66, 45056
s_nop 0
buffer_load_dwordx4 v10, s[12:15], m0 offen nt lds
s_xor_b32 m0, s66, 49152
s_nop 0
buffer_load_dwordx4 v10, s[12:15], m0 offen nt lds
s_xor_b32 m0, s66, 53248
s_nop 0
buffer_load_dwordx4 v10, s[12:15], m0 offen nt lds
s_xor_b32 m0, s66, 57344
s_nop 0
buffer_load_dwordx4 v10, s[12:15], m0 offen nt lds
s_xor_b32 m0, s66, 61440
s_nop 0
buffer_load_dwordx4 v10, s[12:15], m0 offen nt lds
s_and_b32 s52, s6, 1
s_lshl_b32 s52, s52, 1
v_and_b32 v252, 1, v3
v_or_b32 v252, s52, v252
v_lshlrev_b32 v252, 1, v252
v_xor_b32 v252, v252, v2
v_lshlrev_b32 v252, 4, v252
v_lshl_add_u32 v252, v3, 8, v252
s_lshr_b32 s52, s98, 5
s_and_b32 s52, s52, 128
v_xor_b32 v252, s52, v252
v_xor_b32 v253, 128, v252
s_mov_b32 s18, 65536
s_mov_b32 s19, 0x20000
s_xor_b32 m0, s67, 0
s_nop 0
buffer_load_dwordx4 v252, s[16:19], m0 offen nt lds
s_xor_b32 m0, s67, 4096
s_nop 0
buffer_load_dwordx4 v253, s[16:19], m0 offen nt lds
s_getreg_b32 s99, hwreg(HW_REG_XCC_ID)
s_and_b32 s99, s99, 7
s_cmp_lg_u32 s6, 3
s_cbranch_scc1 L_nordy
s_lshl_b32 s52, s4, 7
s_lshl_b32 s53, s5, 2
s_add_u32 s52, s52, s53
s_add_u32 s52, s52, 1773568
v_mov_b32 v254, s52
s_or_b32 s52, s68, s99
v_mov_b32 v255, s52
s_mov_b64 exec, 1
s_waitcnt vmcnt(13)
buffer_store_dword v255, v254, s[32:35], 0 offen sc1
s_mov_b64 exec, -1
L_nordy:
s_lshr_b32 s52, s5, 4
s_lshl_b32 s52, s52, 12
v_lshl_add_u32 v37, v0, 4, s52
v_lshlrev_b32 v64, 1, v37
buffer_load_dwordx4 v[92:95], v64, s[32:35], s69 offen sc1
buffer_load_dwordx4 v[96:99], v64, s[32:35], s69 offen offset:16 sc1
s_xor_b32 m0, s67, 8192
s_nop 0
buffer_load_dwordx4 v252, s[16:19], m0 offen nt lds
s_xor_b32 m0, s67, 12288
s_nop 0
buffer_load_dwordx4 v253, s[16:19], m0 offen nt lds
s_xor_b32 m0, s67, 16384
s_nop 0
buffer_load_dwordx4 v252, s[16:19], m0 offen nt lds
s_xor_b32 m0, s67, 20480
s_nop 0
buffer_load_dwordx4 v253, s[16:19], m0 offen nt lds
s_xor_b32 m0, s67, 24576
s_nop 0
buffer_load_dwordx4 v252, s[16:19], m0 offen nt lds
s_xor_b32 m0, s67, 28672
s_nop 0
buffer_load_dwordx4 v253, s[16:19], m0 offen nt lds
s_xor_b32 m0, s67, 32768
s_nop 0
buffer_load_dwordx4 v252, s[16:19], m0 offen nt lds
s_xor_b32 m0, s67, 36864
s_nop 0
buffer_load_dwordx4 v253, s[16:19], m0 offen nt lds
s_xor_b32 m0, s67, 40960
s_nop 0
buffer_load_dwordx4 v252, s[16:19], m0 offen nt lds
s_xor_b32 m0, s67, 45056
s_nop 0
buffer_load_dwordx4 v253, s[16:19], m0 offen nt lds
s_mov_b32 s30, 5308416
s_mov_b32 s31, 0x20000
s_mov_b32 s42, 9216
s_mov_b32 s43, 0x20000
s_mov_b32 s46, 1152
s_mov_b32 s47, 0x20000
s_mov_b32 s9, 0
s_mov_b32 s10, 0
s_mov_b32 s58, s11
s_cmp_ge_u32 s5, 18
s_cselect_b32 s8, 1, 0
s_cselect_b32 s24, s92, s24
s_cselect_b32 s25, s93, s25
s_mov_b32 s26, 4718592
s_cselect_b32 s26, 5308416, s26
s_mov_b32 s27, 0x20000
s_cmp_ge_u32 s5, 30
s_cselect_b32 s8, 2, s8
s_cmp_ge_u32 s5, 9
s_cselect_b32 s96, 1, 0
s_mul_i32 s52, s96, 9
s_sub_u32 s97, s5, s52
s_sub_u32 s52, s5, 18
s_and_b32 s53, s52, 3
s_lshr_b32 s52, s52, 2
s_and_b32 s52, s52, 3
s_cmp_eq_u32 s8, 0
s_cselect_b32 s96, s96, s53
s_cselect_b32 s97, s97, s52
v_mov_b32 v4, 0x3f803f80
v_mov_b32 v5, 0x3f803f80
s_cmp_eq_u32 s6, 0
s_cselect_b32 s52, 0x3f803f80, 0
s_cselect_b64 s[70:71], 1, 0
v_mov_b32 v6, s52
v_mov_b32 v7, s52
v_mov_b32 v59, 1.736111111e-03
s_mov_b32 s60, 0xffff0000
s_mov_b32 s61, 0xffff0000
s_mov_b32 s72, 0xaaaaaaaa
s_mov_b32 s73, 0xaaaaaaaa
s_mov_b32 s90, 0x0
s_mov_b32 s91, 0xffff0000
v_mov_b32 v104, v4
v_mov_b32 v105, v4
v_mov_b32 v106, v4
v_mov_b32 v107, v4
v_mov_b32 v108, 0
v_mov_b32 v109, 0
v_mov_b32 v110, v4
v_mov_b32 v111, v4
v_mov_b32 v47, 0
v_mov_b32 v48, 0
v_mov_b32 v49, 0
v_mov_b32 v50, 0
v_mov_b32 v51, 0
v_mov_b32 v52, 0
v_mov_b32 v53, 0
v_mov_b32 v54, 0
v_mov_b32 v55, 0
v_mov_b32 v56, 0
v_mov_b32 v57, 0
v_mov_b32 v58, 0
v_mov_b32 v27, 0
v_mov_b32 v63, 0
v_mov_b32 v13, 0
v_mfma_f32_16x16x32_bf16 v[112:115], v[104:107], a[64:67], 0
v_mfma_f32_16x16x32_bf16 v[112:115], v[104:107], a[68:71], v[112:115]
v_mfma_f32_16x16x32_bf16 v[112:115], v[104:107], a[72:75], v[112:115]
v_mfma_f32_16x16x32_bf16 v[112:115], v[104:107], a[76:79], v[112:115]
v_mfma_f32_16x16x32_bf16 v[112:115], v[108:111], a[78:81], v[112:115]
v_lshrrev_b32 v34, 2, v1
v_mul_u32_u24 v34, 288, v34
v_and_b32 v33, 3, v1
v_lshl_add_u32 v34, v33, 3, v34
s_lshl_b32 s52, s6, 5
s_add_u32 s52, s52, 158848
v_add_u32 v33, s52, v34
v_add_u32 v34, 159104, v34
s_lshl_b32 s52, s62, 5
s_lshl_b32 s53, s6, 3
s_add_u32 s52, s52, s53
s_add_u32 s52, s52, 26624
v_mov_b32 v36, s52
v_lshrrev_b32 v68, 7, v0
v_mul_u32_u24 v68, 128, v68
v_lshl_add_u32 v39, v0, 1, v68
v_add_u32 v39, 153600, v39
ds_write_b16 v39, v108 offset:1600
ds_write_b16 v39, v108 offset:2400
v_mov_b32 v68, 158784
ds_read_b32 v205, v68
v_mov_b32 v204, 0
v_mov_b32 v12, v112
v_add_u32 v67, 256, v1
v_min_u32 v67, 287, v67
v_mul_u32_u24 v28, 3641, v0
v_lshrrev_b32 v28, 16, v28
v_mul_u32_u24 v68, 18, v28
v_sub_u32 v68, v0, v68
v_lshlrev_b32 v68, 4, v68
v_and_b32 v69, 3, v28
v_lshl_add_u32 v68, v69, 11, v68
v_lshrrev_b32 v28, 2, v28
v_lshl_add_u32 v28, v28, 14, v68
s_mul_i32 s52, s62, 288
v_add_u32 v28, s52, v28
v_mul_u32_u24 v29, 3641, v67
v_lshrrev_b32 v29, 16, v29
v_mul_u32_u24 v68, 18, v29
v_sub_u32 v68, v67, v68
v_lshlrev_b32 v68, 4, v68
v_and_b32 v69, 3, v29
v_lshl_add_u32 v68, v69, 11, v68
v_lshrrev_b32 v29, 2, v29
v_lshl_add_u32 v29, v29, 14, v68
s_mul_i32 s52, s62, 288
v_add_u32 v29, s52, v29
v_lshlrev_b32 v38, 3, v2
v_add_u32 v38, 26624, v38
v_lshrrev_b32 v68, 3, v2
v_mul_u32_u24 v43, 640, v68
v_mul_u32_u24 v40, 384, v68
v_and_b32 v68, 3, v2
v_mul_u32_u24 v69, 800, v68
v_add_u32 v40, v40, v69
v_lshl_add_u32 v40, v3, 4, v40
v_add_u32 v40, 153600, v40
v_lshl_add_u32 v43, v3, 4, v43
v_add_u32 v43, 156800, v43
v_lshrrev_b32 v69, 5, v1
v_mul_u32_u24 v41, 640, v69
v_and_b32 v42, 31, v1
v_lshl_add_u32 v41, v42, 2, v41
s_lshl_b32 s52, s6, 7
s_add_u32 s52, s52, 156800
v_add_u32 v41, s52, v41
v_lshlrev_b32 v44, 4, v69
s_lshl_b32 s52, s6, 2
s_add_u32 s52, s52, 158080
v_add_u32 v42, s52, v44
v_lshl_add_u32 v44, v68, 2, v44
v_add_u32 v44, 158080, v44
v_min_u32 v46, 17, v1
v_lshlrev_b32 v46, 2, v46
v_add_u32 v46, 26880, v46
s_lshl_b32 s52, s5, 9
s_lshl_b32 s53, s6, 6
s_add_u32 s52, s52, s53
s_add_u32 s52, s52, 28672
v_lshlrev_b32 v45, 8, v69
v_lshl_add_u32 v45, v2, 2, v45
v_add_u32 v45, s52, v45
s_lshl_b32 s52, s5, 6
s_add_u32 s52, s52, 45056
s_lshl_b32 s53, s6, 2
s_add_u32 s53, s53, s52
v_lshl_add_u32 v68, v69, 4, s53
s_lshl_b32 s53, s6, 3
s_add_u32 s53, s53, s52
s_add_u32 s53, s53, 32
v_lshl_add_u32 v69, v69, 2, s53
v_cndmask_b32 v68, v68, v69, s[72:73]
v_cndmask_b32 v45, v45, v68, s[60:61]
s_mov_b32 s48, 0x1ffff
s_cmp_lt_u32 s6, 2
s_cselect_b32 s48, 0x3ffff, s48
s_mov_b32 s49, s48
s_lshl_b32 s52, s6, 14
s_add_u32 s52, s52, 65536
v_lshl_add_u32 v248, v2, 8, s52
v_xor_b32 v249, v3, v2
v_xor_b32 v68, 0, v249
v_lshl_add_u32 v68, v68, 4, v248
v_xor_b32 v69, 4, v249
v_lshl_add_u32 v69, v69, 4, v248
v_xor_b32 v70, 8, v249
v_lshl_add_u32 v70, v70, 4, v248
v_xor_b32 v71, 12, v249
v_lshl_add_u32 v71, v71, 4, v248
v_mov_b32 v250, 158788
s_waitcnt vmcnt(10)
v_xor_b32 v248, s68, v93
v_xor_b32 v249, s68, v95
v_or_b32 v248, v248, v249
v_xor_b32 v249, s68, v97
v_or_b32 v248, v248, v249
v_xor_b32 v249, s68, v99
v_or_b32 v248, v248, v249
v_cmp_ne_u32 vcc, 0, v248
s_mov_b64 exec, vcc
ds_write_b32 v250, v4
s_mov_b64 exec, -1
s_waitcnt lgkmcnt(0)
s_barrier
ds_read_b32 v251, v250
ds_read_b128 v[128:131], v68 offset:0
ds_read_b128 v[132:135], v69 offset:0
ds_read_b128 v[136:139], v70 offset:0
ds_read_b128 v[140:143], v71 offset:0
ds_read_b128 v[144:147], v68 offset:4096
ds_read_b128 v[148:151], v69 offset:4096
ds_read_b128 v[152:155], v70 offset:4096
ds_read_b128 v[156:159], v71 offset:4096
s_waitcnt lgkmcnt(8)
v_readfirstlane_b32 s52, v251
ds_read_b128 v[160:163], v68 offset:8192
ds_read_b128 v[164:167], v69 offset:8192
ds_read_b128 v[168:171], v70 offset:8192
ds_read_b128 v[172:175], v71 offset:8192
ds_read_b128 v[176:179], v68 offset:12288
ds_read_b128 v[180:183], v69 offset:12288
ds_read_b128 v[184:187], v70 offset:12288
ds_read_b128 v[188:191], v71 offset:12288
s_cmp_eq_u32 s52, 0
s_cbranch_scc1 L_q0_ok
s_mov_b64 exec, 0xffff
buffer_store_dwordx2 v[60:61], v62, s[32:35], s69 offen sc1
s_mov_b64 exec, -1
s_mov_b32 s57, 0
L_q0_chk:
v_xor_b32 v248, s68, v93
v_xor_b32 v249, s68, v95
v_or_b32 v248, v248, v249
v_xor_b32 v249, s68, v97
v_or_b32 v248, v248, v249
v_xor_b32 v249, s68, v99
v_or_b32 v248, v248, v249
v_cmp_ne_u32 vcc, 0, v248
s_cbranch_vccz L_q0_ok
s_add_u32 s57, s57, 1
s_cmp_ge_u32 s57, 1048576
s_cbranch_scc1 L_end
buffer_load_dwordx4 v[92:95], v64, s[32:35], s69 offen sc1
buffer_load_dwordx4 v[96:99], v64, s[32:35], s69 offen offset:16 sc1
s_waitcnt vmcnt(0)
s_branch L_q0_chk
L_q0_ok:
v_mov_b32 v200, v92
v_mov_b32 v201, v94
v_mov_b32 v202, v96
v_mov_b32 v203, v98
s_branch L_att_ok
L_rc11:
s_mov_b32 s57, 0
L_rct12:
buffer_load_dwordx2 v[204:205], v38, s[32:35], s58 offen sc1
s_waitcnt vmcnt(0)
v_max_u32 v243, v204, v205
v_cmp_eq_u32 vcc, -1, v243
s_cbranch_vccz L_rcb13
s_add_u32 s57, s57, 1
s_cmp_lt_u32 s57, 1048576
s_cbranch_scc1 L_rct12
s_branch L_end
L_slow14:
buffer_store_dword v254, v45, s[32:35], s58 offen sc1
s_branch L_back15
L_slow17:
buffer_store_dword v12, v35, s[32:35], s11 offen sc1
s_branch L_back18
L_slow19:
buffer_store_dword v254, v45, s[32:35], s58 offen sc1
s_branch L_back20
L_walk0_1:
s_branch L_walk0_2
L_rdy:
v_lshlrev_b32 v220, 4, v1
v_add_u32 v220, 1773568, v220
s_lshl_b32 s52, s97, 7
s_lshl_b32 s53, s6, 5
s_add_u32 s52, s52, s53
v_lshl_add_u32 v68, v3, 3, s52
buffer_load_dwordx2 v[22:23], v68, s[36:39], 0 offen
s_cmp_eq_u32 s8, 1
s_cbranch_scc1 L_rb16
s_cmp_eq_u32 s8, 2
s_cbranch_scc1 L_w1_issuedf
v_lshrrev_b32 v68, 5, v1
s_and_b32 s52, s6, 2
v_or_b32 v68, s52, v68
v_lshlrev_b32 v68, 1, v68
v_xor_b32 v68, v68, v1
v_and_b32 v68, 7, v68
v_lshlrev_b32 v68, 4, v68
v_lshrrev_b32 v69, 3, v1
s_mov_b32 s52, 1152
v_mad_u32_u24 v68, v69, s52, v68
s_lshl_b32 s53, s4, 1
s_add_u32 s53, s53, s96
s_lshl_b32 s53, s53, 5
s_add_u32 s53, s53, s6
s_mul_i32 s53, s53, 9216
s_lshl_b32 s54, s97, 7
s_add_u32 s53, s53, s54
s_lshl_b32 s54, s6, 10
s_add_u32 s54, s54, 65536
s_mov_b32 m0, s54
s_nop 0
buffer_load_dwordx4 v68, s[24:27], s53 offen nt lds
s_add_u32 s53, s53, 36864
s_add_u32 s54, s54, 4096
s_mov_b32 m0, s54
s_nop 0
buffer_load_dwordx4 v68, s[24:27], s53 offen nt lds
s_add_u32 s53, s53, 36864
s_add_u32 s54, s54, 4096
s_mov_b32 m0, s54
s_nop 0
buffer_load_dwordx4 v68, s[24:27], s53 offen nt lds
s_add_u32 s53, s53, 36864
s_add_u32 s54, s54, 4096
s_mov_b32 m0, s54
s_nop 0
buffer_load_dwordx4 v68, s[24:27], s53 offen nt lds
s_add_u32 s53, s53, 36864
s_add_u32 s54, s54, 4096
s_mov_b32 m0, s54
s_nop 0
buffer_load_dwordx4 v68, s[24:27], s53 offen nt lds
s_add_u32 s53, s53, 36864
s_add_u32 s54, s54, 4096
s_mov_b32 m0, s54
s_nop 0
buffer_load_dwordx4 v68, s[24:27], s53 offen nt lds
s_add_u32 s53, s53, 36864
s_add_u32 s54, s54, 4096
s_mov_b32 m0, s54
s_nop 0
buffer_load_dwordx4 v68, s[24:27], s53 offen nt lds
s_add_u32 s53, s53, 36864
s_add_u32 s54, s54, 4096
s_mov_b32 m0, s54
s_nop 0
buffer_load_dwordx4 v68, s[24:27], s53 offen nt lds
s_branch L_w1_issued
L_walk0_2:
s_branch L_walk0_3
L_rb16:
v_bfe_u32 v68, v1, 4, 1
s_and_b32 s52, s6, 1
s_lshl_b32 s52, s52, 1
v_or_b32 v68, s52, v68
v_lshlrev_b32 v68, 1, v68
v_xor_b32 v68, v68, v1
v_and_b32 v68, 7, v68
v_lshlrev_b32 v68, 4, v68
v_lshrrev_b32 v69, 3, v1
s_mov_b32 s52, 9216
v_mad_u32_u24 v68, v69, s52, v68
s_mul_i32 s53, s96, 18
s_add_u32 s53, s53, s6
s_mul_i32 s53, s53, 73728
s_mul_i32 s54, s4, 1152
s_add_u32 s53, s53, s54
s_mul_i32 s54, s97, 384
s_add_u32 s53, s53, s54
s_lshl_b32 s54, s6, 10
s_add_u32 s54, s54, 65536
s_add_u32 s55, s53, 0
s_add_u32 s56, s54, 0
s_mov_b32 m0, s56
s_nop 0
buffer_load_dwordx4 v68, s[24:27], s55 offen nt lds
s_add_u32 s55, s53, 128
s_add_u32 s56, s54, 18432
s_mov_b32 m0, s56
s_nop 0
buffer_load_dwordx4 v68, s[24:27], s55 offen nt lds
s_add_u32 s55, s53, 256
s_add_u32 s56, s54, 36864
s_mov_b32 m0, s56
s_nop 0
buffer_load_dwordx4 v68, s[24:27], s55 offen nt lds
L_w1_issuedb:
L_w1_issuedf:
L_w1_issued:
buffer_load_dwordx4 v[212:215], v220, s[32:35], 0 offen sc1
s_xor_b32 m0, s67, 49152
s_nop 0
buffer_load_dwordx4 v252, s[16:19], m0 offen nt lds
s_xor_b32 m0, s67, 53248
s_nop 0
buffer_load_dwordx4 v253, s[16:19], m0 offen nt lds
s_xor_b32 m0, s67, 57344
s_nop 0
buffer_load_dwordx4 v252, s[16:19], m0 offen nt lds
s_xor_b32 m0, s67, 61440
s_nop 0
buffer_load_dwordx4 v253, s[16:19], m0 offen nt lds
s_mov_b32 s98, 0
v_bfe_u32 v11, v1, 3, 2
v_bfe_u32 v68, v1, 2, 1
v_lshl_or_b32 v11, v68, 2, v11
s_lshl_b32 s52, s6, 1
v_xor_b32 v11, s52, v11
v_lshlrev_b32 v11, 5, v11
v_and_b32 v10, 3, v1
v_lshl_add_u32 v10, v10, 3, v11
v_lshl_add_u32 v10, v68, 12, v10
v_bfe_u32 v68, v1, 3, 1
v_lshl_add_u32 v10, v68, 8, v10
v_lshl_add_u32 v10, v3, 10, v10
v_xor_b32 v11, 32, v10
s_cmp_eq_u32 s8, 1
s_cbranch_scc1 L_sub
s_cmp_eq_u32 s8, 2
s_cbranch_scc1 L_sud
s_and_b32 s52, s6, 1
s_lshl_b32 s52, s52, 1
v_lshrrev_b32 v72, 3, v2
v_add_u32 v72, s52, v72
v_and_b32 v73, 1, v2
v_lshlrev_b32 v73, 4, v73
v_mov_b32 v74, 0x3d80
v_lshlrev_b32 v73, v73, v74
v_cmp_eq_u32 vcc, v72, v3
v_bfe_u32 v74, v2, 1, 2
s_nop 0
v_cndmask_b32 v73, 0, v73, vcc
v_cmp_eq_u32 vcc, 0, v74
s_nop 1
v_cndmask_b32 v16, 0, v73, vcc
v_cmp_eq_u32 vcc, 1, v74
s_nop 1
v_cndmask_b32 v17, 0, v73, vcc
v_cmp_eq_u32 vcc, 2, v74
s_nop 1
v_cndmask_b32 v18, 0, v73, vcc
v_cmp_eq_u32 vcc, 3, v74
s_nop 1
v_cndmask_b32 v19, 0, v73, vcc
v_lshrrev_b32 v47, 2, v2
v_lshlrev_b32 v47, 14, v47
v_and_b32 v72, 3, v2
v_lshl_add_u32 v47, v72, 11, v47
v_lshl_add_u32 v47, v3, 4, v47
s_lshl_b32 s52, s97, 7
s_lshr_b32 s53, s6, 1
s_lshl_b32 s53, s53, 6
s_add_u32 s52, s52, s53
v_add_u32 v47, s52, v47
s_lshl_b32 s52, s96, 13
s_lshl_b32 s53, s6, 11
s_add_u32 s52, s52, s53
s_add_u32 s52, s52, 28672
v_lshl_add_u32 v48, v1, 4, s52
s_lshl_b32 s52, s96, 10
s_add_u32 s52, s52, 45056
v_lshl_add_u32 v49, v2, 6, s52
v_min_u32 v72, 2, v3
v_lshl_add_u32 v49, v72, 4, v49
s_mul_i32 s52, s6, 2176
s_add_u32 s52, s52, 135168
v_lshrrev_b32 v50, 5, v1
v_mul_u32_u24 v50, 544, v50
v_and_b32 v72, 31, v1
v_lshl_add_u32 v50, v72, 4, v50
v_add_u32 v50, s52, v50
v_mul_u32_u24 v51, 544, v2
v_lshl_add_u32 v51, v3, 4, v51
v_add_u32 v51, 135168, v51
s_lshl_b32 s52, s4, 1
s_add_u32 s52, s52, s96
s_lshr_b32 s53, s52, 2
s_lshl_b32 s53, s53, 14
s_and_b32 s52, s52, 3
s_lshl_b32 s52, s52, 11
s_add_u32 s52, s52, s53
s_lshl_b32 s53, s97, 7
s_add_u32 s52, s52, s53
v_and_b32 v13, 7, v1
v_lshlrev_b32 v13, 4, v13
v_add_u32 v52, s52, v13
v_bfe_u32 v63, v1, 3, 1
v_lshl_add_u32 v52, v63, 13, v52
v_add_u32 v13, 163456, v13
s_lshl_b32 s53, s6, 5
s_add_u32 s53, s53, 163456
v_lshl_add_u32 v63, v3, 3, s53
s_lshl_b32 s52, s5, 2
s_add_u32 s52, s52, 26880
v_mov_b32 v53, s52
s_mul_i32 s52, s96, 4608
s_mul_i32 s53, s6, 1152
s_add_u32 s52, s52, s53
s_add_u32 s52, s52, 8192
v_lshl_add_u32 v54, v1, 4, s52
s_add_u32 s52, s52, 1024
v_lshl_add_u32 v55, v2, 4, s52
v_lshlrev_b32 v72, 4, v2
v_add_u32 v72, 26624, v72
v_cmp_gt_u32 vcc, 8, v2
s_mul_i32 s52, s6, 144
s_add_u32 s52, s52, 158144
v_cndmask_b32 v55, v72, v55, vcc
v_lshl_add_u32 v56, v1, 1, s52
s_add_u32 s52, s52, 128
v_lshl_add_u32 v57, v2, 1, s52
v_mov_b32 v72, 158720
v_cndmask_b32 v57, v72, v57, vcc
v_lshlrev_b32 v58, 4, v3
v_add_u32 v58, 158144, v58
v_bfe_u32 v72, v1, 4, 1
v_bfe_u32 v73, v1, 2, 1
v_lshl_or_b32 v72, v73, 1, v72
v_xor_b32 v72, s6, v72
v_lshlrev_b32 v72, 5, v72
v_lshl_add_u32 v72, v73, 11, v72
v_and_b32 v73, 3, v1
v_lshl_add_u32 v72, v73, 3, v72
v_bfe_u32 v73, v1, 3, 1
v_lshl_add_u32 v72, v73, 7, v72
v_lshl_add_u32 v72, v3, 9, v72
v_add_u32 v72, 65536, v72
s_branch L_sud
L_walk0_3:
s_branch L_walk0_4
L_sub:
v_add_u32 v75, 256, v1
v_min_u32 v75, 287, v75
v_mul_u32_u24 v48, 3641, v0
v_lshrrev_b32 v48, 16, v48
v_mul_u32_u24 v76, 18, v48
v_sub_u32 v76, v0, v76
v_lshlrev_b32 v76, 4, v76
v_and_b32 v77, 3, v48
v_lshl_add_u32 v76, v77, 11, v76
v_lshrrev_b32 v48, 2, v48
v_lshl_add_u32 v48, v48, 14, v76
s_mul_i32 s52, s96, 288
v_add_u32 v48, s52, v48
v_mul_u32_u24 v49, 3641, v75
v_lshrrev_b32 v49, 16, v49
v_mul_u32_u24 v76, 18, v49
v_sub_u32 v76, v75, v76
v_lshlrev_b32 v76, 4, v76
v_and_b32 v77, 3, v49
v_lshl_add_u32 v76, v77, 11, v76
v_lshrrev_b32 v49, 2, v49
v_lshl_add_u32 v49, v49, 14, v76
s_mul_i32 s52, s96, 288
v_add_u32 v49, s52, v49
s_mul_i32 s52, s97, 3072
s_lshl_b32 s53, s6, 8
s_add_u32 s52, s52, s53
s_lshl_b32 s53, s96, 2
s_add_u32 s52, s52, s53
s_add_u32 s52, s52, 8192
v_lshl_add_u32 v50, v2, 4, s52
v_and_b32 v72, 1, v3
v_lshl_add_u32 v50, v72, 11, v50
v_lshrrev_b32 v72, 1, v3
v_lshl_add_u32 v50, v72, 10, v50
v_add_u32 v27, 9216, v50
s_lshl_b32 s52, s96, 5
s_lshl_b32 s53, s6, 3
s_add_u32 s52, s52, s53
s_add_u32 s52, s52, 26752
v_lshl_add_u32 v72, v2, 2, s52
v_cndmask_b32 v50, v50, v72, s[90:91]
s_mov_b32 s50, -1
s_mov_b32 s51, 0xffff
s_cmp_eq_u32 s97, 0
s_cselect_b32 s51, 0x3ffff, s51
v_bfe_u32 v72, v1, 3, 2
v_xor_b32 v72, s6, v72
v_lshlrev_b32 v72, 5, v72
v_and_b32 v73, 3, v1
v_lshl_add_u32 v72, v73, 3, v72
v_bfe_u32 v73, v1, 2, 2
v_lshl_add_u32 v72, v73, 7, v72
v_lshl_add_u32 v72, v3, 10, v72
v_add_u32 v72, 65536, v72
v_bfe_u32 v74, v1, 3, 1
v_and_b32 v75, 2, v3
v_or_b32 v74, v74, v75
v_xor_b32 v74, s6, v74
v_lshlrev_b32 v74, 5, v74
v_and_b32 v75, 3, v1
v_lshl_add_u32 v74, v75, 3, v74
v_lshrrev_b32 v75, 2, v1
v_lshl_add_u32 v74, v75, 7, v74
v_add_u32 v74, 81920, v74
L_sud:
s_cmp_eq_u32 s8, 1
s_cbranch_scc1 L_s1b
s_cmp_eq_u32 s8, 0
s_cbranch_scc1 L_s1a
s_waitcnt vmcnt(5)
L_s1b:
s_waitcnt vmcnt(8)
L_s1a:
s_waitcnt vmcnt(13) lgkmcnt(0)
s_barrier
ds_read_b64_tr_b16 a[0:1], v10 offset:0
ds_read_b64_tr_b16 a[2:3], v10 offset:512
ds_read_b64_tr_b16 a[4:5], v11 offset:0
ds_read_b64_tr_b16 a[6:7], v11 offset:512
ds_read_b64_tr_b16 a[8:9], v10 offset:8192
ds_read_b64_tr_b16 a[10:11], v10 offset:8704
ds_read_b64_tr_b16 a[12:13], v11 offset:8192
ds_read_b64_tr_b16 a[14:15], v11 offset:8704
ds_read_b64_tr_b16 a[16:17], v10 offset:16384
ds_read_b64_tr_b16 a[18:19], v10 offset:16896
ds_read_b64_tr_b16 a[20:21], v11 offset:16384
ds_read_b64_tr_b16 a[22:23], v11 offset:16896
ds_read_b64_tr_b16 a[24:25], v10 offset:24576
ds_read_b64_tr_b16 a[26:27], v10 offset:25088
ds_read_b64_tr_b16 a[28:29], v11 offset:24576
ds_read_b64_tr_b16 a[30:31], v11 offset:25088
v_mov_b32 v233, v72
v_lshlrev_b32 v20, 16, v22
v_and_b32 v21, 0xffff0000, v22
v_lshlrev_b32 v22, 16, v23
v_and_b32 v23, 0xffff0000, v23
v_mul_f32 v20, 0x3b800000, v20
v_mul_f32 v21, 0x3b800000, v21
v_mul_f32 v22, 0x3b800000, v22
v_mul_f32 v23, 0x3b800000, v23
ds_read_b32 v247, v44
ds_read_b128 v[64:67], v43 offset:0
ds_read_b128 v[68:71], v43 offset:64
ds_read_b128 v[72:75], v43 offset:128
ds_read_b128 v[76:79], v43 offset:192
ds_read_b128 v[80:83], v43 offset:256
ds_read_b128 v[84:87], v43 offset:320
ds_read_b128 v[88:91], v43 offset:384
ds_read_b128 v[92:95], v43 offset:448
s_waitcnt lgkmcnt(0)
v_mfma_f32_16x16x32_bf16 v[96:99], v[64:67], a[0:3], 0
v_add_f32_dpp v246, v246, v246 quad_perm:[2,3,0,1] row_mask:0xf bank_mask:0xf
v_max_f32_dpp v249, v247, v247 quad_perm:[1,0,3,2] row_mask:0xf bank_mask:0xf
v_mfma_f32_16x16x32_bf16 v[100:103], v[64:67], a[4:7], 0
v_add_f32_dpp v246, v246, v246 row_half_mirror row_mask:0xf bank_mask:0xf
v_max_f32_dpp v249, v249, v249 quad_perm:[2,3,0,1] row_mask:0xf bank_mask:0xf
v_mfma_f32_16x16x32_bf16 v[96:99], v[68:71], a[8:11], v[96:99]
v_add_f32_dpp v246, v246, v246 row_mirror row_mask:0xf bank_mask:0xf
v_sub_f32 v247, v247, v249
v_mfma_f32_16x16x32_bf16 v[100:103], v[68:71], a[12:15], v[100:103]
v_sub_f32 v248, v248, v249
v_exp_f32 v247, v247
v_mfma_f32_16x16x32_bf16 v[104:107], v[72:75], a[16:19], 0
v_exp_f32 v248, v248
s_nop 0
v_mfma_f32_16x16x32_bf16 v[108:111], v[72:75], a[20:23], 0
v_mul_f32 v246, v246, v248
v_cndmask_b32 v246, v246, v249, s[72:73]
v_mfma_f32_16x16x32_bf16 v[104:107], v[76:79], a[24:27], v[104:107]
v_mfma_f32_16x16x32_bf16 v[108:111], v[76:79], a[28:31], v[108:111]
s_nop 7
v_mul_f32_dpp v254, v247, v96 row_newbcast:0 row_mask:0xf bank_mask:0xf
v_mul_f32_dpp v248, v247, v100 row_newbcast:0 row_mask:0xf bank_mask:0xf
s_nop 0
v_fmac_f32_dpp v254, v247, v104 row_newbcast:1 row_mask:0xf bank_mask:0xf
v_fmac_f32_dpp v248, v247, v108 row_newbcast:1 row_mask:0xf bank_mask:0xf
s_mov_b32 s57, 0
s_waitcnt vmcnt(4)
L_rdy_chk:
v_xor_b32 v216, s68, v212
v_xor_b32 v217, s68, v213
v_xor_b32 v218, s68, v214
v_xor_b32 v219, s68, v215
v_or_b32 v224, v216, v217
v_or3_b32 v224, v224, v218, v219
v_cmp_lt_u32 vcc, 7, v224
s_cbranch_vccz L_rdy_ok
s_add_u32 s57, s57, 1
s_cmp_ge_u32 s57, 1048576
s_cbranch_scc1 L_end
s_sleep 16
buffer_load_dwordx4 v[212:215], v220, s[32:35], 0 offen sc1
s_waitcnt vmcnt(0)
s_branch L_rdy_chk
L_rdy_ok:
v_xor_b32 v216, s99, v216
v_xor_b32 v217, s99, v217
v_xor_b32 v218, s99, v218
v_xor_b32 v219, s99, v219
v_or_b32 v224, v216, v217
v_or3_b32 v224, v224, v218, v219
v_cmp_ne_u32 vcc, 0, v224
s_lshl_b32 s53, s4, 3
s_lshr_b64 s[54:55], vcc, s53
s_and_b32 s54, s54, 0xff
s_cselect_b32 s9, 0, 1
s_cmp_lg_u32 s9, 0
s_cbranch_scc1 L_nore
s_mov_b64 exec, 0xffff
buffer_store_dwordx2 v[60:61], v62, s[32:35], s69 offen sc1
s_mov_b64 exec, -1
s_waitcnt vmcnt(0)
L_nore:
s_mul_i32 s53, s5, 896
s_lshl_b32 s54, s6, 8
s_add_u32 s53, s53, s54
s_sub_u32 s53, s53, 256
v_lshl_add_u32 v225, v1, 7, s53
s_lshl_b32 s53, s5, 9
s_lshl_b32 s54, s6, 7
s_add_u32 s53, s53, s54
s_add_u32 s53, s53, 28672
s_lshl_b32 s54, s5, 6
s_add_u32 s54, s54, 45056
v_writelane_b32 v225, s53, 0
v_writelane_b32 v225, s54, 1
s_mov_b64 exec, 15
buffer_load_dword v8, v225, s[32:35], s11 offen sc1
s_mov_b64 exec, -1
s_cmp_eq_u32 s9, 0
s_mov_b64 exec, 0xffff
s_cbranch_scc1 L_slow17
buffer_store_dword v12, v35, s[32:35], s11 offen
L_back18:
s_mov_b64 exec, -1
s_waitcnt vmcnt(2)
L_bb2:
s_barrier
ds_read_b64_tr_b16 a[32:33], v10 offset:32768
ds_read_b64_tr_b16 a[34:35], v10 offset:33280
ds_read_b64_tr_b16 a[36:37], v11 offset:32768
ds_read_b64_tr_b16 a[38:39], v11 offset:33280
ds_read_b64_tr_b16 a[40:41], v10 offset:40960
ds_read_b64_tr_b16 a[42:43], v10 offset:41472
ds_read_b64_tr_b16 a[44:45], v11 offset:40960
ds_read_b64_tr_b16 a[46:47], v11 offset:41472
ds_read_b64_tr_b16 a[48:49], v10 offset:49152
ds_read_b64_tr_b16 a[50:51], v10 offset:49664
ds_read_b64_tr_b16 a[52:53], v11 offset:49152
ds_read_b64_tr_b16 a[54:55], v11 offset:49664
s_waitcnt lgkmcnt(10)
v_mfma_f32_16x16x32_bf16 v[112:115], v[80:83], a[32:35], 0
ds_read_b64_tr_b16 a[56:57], v10 offset:57344
s_waitcnt lgkmcnt(9)
v_mfma_f32_16x16x32_bf16 v[116:119], v[80:83], a[36:39], 0
ds_read_b64_tr_b16 a[58:59], v10 offset:57856
s_waitcnt lgkmcnt(8)
v_mfma_f32_16x16x32_bf16 v[112:115], v[84:87], a[40:43], v[112:115]
ds_read_b64_tr_b16 a[60:61], v11 offset:57344
s_waitcnt lgkmcnt(7)
v_mfma_f32_16x16x32_bf16 v[116:119], v[84:87], a[44:47], v[116:119]
ds_read_b64_tr_b16 a[62:63], v11 offset:57856
s_waitcnt lgkmcnt(6)
v_mfma_f32_16x16x32_bf16 v[120:123], v[88:91], a[48:51], 0
s_waitcnt lgkmcnt(4)
v_mfma_f32_16x16x32_bf16 v[124:127], v[88:91], a[52:55], 0
s_waitcnt lgkmcnt(2)
v_mfma_f32_16x16x32_bf16 v[120:123], v[92:95], a[56:59], v[120:123]
s_waitcnt lgkmcnt(0)
v_mfma_f32_16x16x32_bf16 v[124:127], v[92:95], a[60:63], v[124:127]
s_nop 1
v_mov_b32 v88, 0
v_mov_b32 v89, 0
v_fmac_f32_dpp v254, v247, v112 row_newbcast:2 row_mask:0xf bank_mask:0xf
v_fmac_f32_dpp v248, v247, v116 row_newbcast:2 row_mask:0xf bank_mask:0xf
s_nop 2
v_fmac_f32_dpp v254, v247, v120 row_newbcast:3 row_mask:0xf bank_mask:0xf
v_fmac_f32_dpp v248, v247, v124 row_newbcast:3 row_mask:0xf bank_mask:0xf
v_cvt_pk_bf16_f32 v254, v254, v248
v_cndmask_b32 v254, v254, v246, s[60:61]
s_cmp_eq_u32 s9, 0
s_mov_b64 exec, s[48:49]
s_cbranch_scc1 L_slow19
buffer_store_dword v254, v45, s[32:35], s58 offen
L_back20:
s_mov_b64 exec, -1
s_cmp_lg_u32 s8, 0
s_cbranch_scc1 L_first
ds_read_b64_tr_b16 a[84:85], v233 offset:0
ds_read_b64_tr_b16 a[86:87], v233 offset:256
ds_read_b64_tr_b16 a[88:89], v233 offset:4096
ds_read_b64_tr_b16 a[90:91], v233 offset:4352
ds_read_b64_tr_b16 a[92:93], v233 offset:8192
ds_read_b64_tr_b16 a[94:95], v233 offset:8448
ds_read_b64_tr_b16 a[96:97], v233 offset:12288
ds_read_b64_tr_b16 a[98:99], v233 offset:12544
ds_read_b64_tr_b16 a[100:101], v233 offset:16384
ds_read_b64_tr_b16 a[102:103], v233 offset:16640
ds_read_b64_tr_b16 a[104:105], v233 offset:20480
ds_read_b64_tr_b16 a[106:107], v233 offset:20736
ds_read_b64_tr_b16 a[108:109], v233 offset:24576
ds_read_b64_tr_b16 a[110:111], v233 offset:24832
ds_read_b64_tr_b16 a[112:113], v233 offset:28672
ds_read_b64_tr_b16 a[114:115], v233 offset:28928
s_branch L_wo_go
L_rc21:
s_mov_b32 s57, 0
L_rct22:
buffer_load_dwordx4 v[208:211], v47, s[32:35], s59 offen sc1
s_waitcnt vmcnt(0)
v_max_u32 v240, v208, v209
v_max3_u32 v240, v240, v210, v211
v_cmp_eq_u32 vcc, -1, v240
s_cbranch_vccz L_rcb23
s_add_u32 s57, s57, 1
s_cmp_lt_u32 s57, 1048576
s_cbranch_scc1 L_rct22
s_branch L_end
L_slow26:
buffer_store_dword v1, v53, s[32:35], s58 offen offset:0 sc1
s_branch L_back27
L_rc29:
s_mov_b32 s57, 0
L_rct30:
buffer_load_dwordx4 v[236:239], v47, s[32:35], s59 offen sc1
s_waitcnt vmcnt(0)
v_max_u32 v241, v236, v237
v_max3_u32 v241, v241, v238, v239
v_cmp_eq_u32 vcc, -1, v241
s_cbranch_vccz L_rcb31
s_add_u32 s57, s57, 1
s_cmp_lt_u32 s57, 1048576
s_cbranch_scc1 L_rct30
s_branch L_end
L_slow33:
buffer_store_dword v1, v53, s[32:35], s58 offen offset:128 sc1
s_branch L_back34
L_slow40:
buffer_store_dword v26, v27, s[32:35], s58 offen sc1
s_branch L_back41
L_walk1_4:
s_branch L_walk1_5
L_hk38:
s_mov_b32 s98, 0
v_mov_b32 v92, v4
v_mov_b32 v93, v4
v_mov_b32 v94, v4
v_mov_b32 v95, v4
v_mov_b32 v96, 0
v_mov_b32 v97, 0
v_mov_b32 v98, v4
v_mov_b32 v99, v4
v_cmp_eq_u32 vcc, 2, v3
s_waitcnt lgkmcnt(0)
v_mfma_f32_16x16x32_bf16 v[104:107], v[92:95], a[84:87], 0
v_mfma_f32_16x16x32_bf16 v[108:111], v[92:95], a[102:105], 0
v_mfma_f32_16x16x32_bf16 v[112:115], v[92:95], a[120:123], 0
v_mfma_f32_16x16x32_bf16 v[104:107], v[92:95], a[88:91], v[104:107]
v_mfma_f32_16x16x32_bf16 v[108:111], v[92:95], a[106:109], v[108:111]
v_mfma_f32_16x16x32_bf16 v[112:115], v[92:95], a[124:127], v[112:115]
v_mfma_f32_16x16x32_bf16 v[104:107], v[92:95], a[92:95], v[104:107]
v_mfma_f32_16x16x32_bf16 v[108:111], v[92:95], a[110:113], v[108:111]
v_mfma_f32_16x16x32_bf16 v[112:115], v[92:95], a[128:131], v[112:115]
v_mfma_f32_16x16x32_bf16 v[104:107], v[92:95], a[96:99], v[104:107]
v_mfma_f32_16x16x32_bf16 v[108:111], v[92:95], a[114:117], v[108:111]
v_mfma_f32_16x16x32_bf16 v[112:115], v[92:95], a[132:135], v[112:115]
v_mfma_f32_16x16x32_bf16 v[104:107], v[96:99], a[98:101], v[104:107]
v_mfma_f32_16x16x32_bf16 v[108:111], v[96:99], a[116:119], v[108:111]
v_mfma_f32_16x16x32_bf16 v[112:115], v[96:99], a[134:137], v[112:115]
s_mov_b32 s54, -1
s_mov_b32 s55, 0xffff
s_nop 4
v_cndmask_b32 v104, v104, v108, vcc
v_cndmask_b32 v26, v104, v112, s[60:61]
s_cmp_eq_u32 s9, 0
s_mov_b64 exec, s[54:55]
s_cbranch_scc1 L_slow40
buffer_store_dword v26, v27, s[32:35], s58 offen
L_back41:
s_mov_b64 exec, -1
s_waitcnt vmcnt(1)
s_branch L_ha39
L_slow47:
buffer_store_dword v26, v27, s[32:35], s58 offen sc1
s_branch L_back48
L_walk1_5:
s_branch L_walked
L_hk45:
s_mov_b32 s98, 0
v_mov_b32 v92, v4
v_mov_b32 v93, v4
v_mov_b32 v94, v4
v_mov_b32 v95, v4
v_mov_b32 v96, 0
v_mov_b32 v97, 0
v_mov_b32 v98, v4
v_mov_b32 v99, v4
v_cmp_eq_u32 vcc, 2, v3
s_waitcnt lgkmcnt(0)
v_mfma_f32_16x16x32_bf16 v[104:107], v[92:95], a[84:87], 0
v_mfma_f32_16x16x32_bf16 v[108:111], v[92:95], a[102:105], 0
v_mfma_f32_16x16x32_bf16 v[112:115], v[92:95], a[120:123], 0
v_mfma_f32_16x16x32_bf16 v[104:107], v[92:95], a[88:91], v[104:107]
v_mfma_f32_16x16x32_bf16 v[108:111], v[92:95], a[106:109], v[108:111]
v_mfma_f32_16x16x32_bf16 v[112:115], v[92:95], a[124:127], v[112:115]
v_mfma_f32_16x16x32_bf16 v[104:107], v[92:95], a[92:95], v[104:107]
v_mfma_f32_16x16x32_bf16 v[108:111], v[92:95], a[110:113], v[108:111]
v_mfma_f32_16x16x32_bf16 v[112:115], v[92:95], a[128:131], v[112:115]
v_mfma_f32_16x16x32_bf16 v[104:107], v[92:95], a[96:99], v[104:107]
v_mfma_f32_16x16x32_bf16 v[108:111], v[92:95], a[114:117], v[108:111]
v_mfma_f32_16x16x32_bf16 v[112:115], v[92:95], a[132:135], v[112:115]
v_mfma_f32_16x16x32_bf16 v[104:107], v[96:99], a[98:101], v[104:107]
v_mfma_f32_16x16x32_bf16 v[108:111], v[96:99], a[116:119], v[108:111]
v_mfma_f32_16x16x32_bf16 v[112:115], v[96:99], a[134:137], v[112:115]
s_mov_b32 s54, -1
s_mov_b32 s55, 0xffff
s_nop 4
v_cndmask_b32 v104, v104, v108, vcc
v_cndmask_b32 v26, v104, v112, s[60:61]
s_cmp_eq_u32 s9, 0
s_mov_b64 exec, s[54:55]
s_cbranch_scc1 L_slow47
buffer_store_dword v26, v27, s[32:35], s58 offen
L_back48:
s_mov_b64 exec, -1
s_waitcnt vmcnt(1)
s_branch L_ha46
L_slow49:
buffer_store_dword v104, v50, s[32:35], s58 offen sc1
s_branch L_back50
L_rc54:
s_mov_b32 s57, 0
L_rct55:
buffer_load_dwordx4 v[92:95], v37, s[32:35], s11 offen sc1
s_waitcnt vmcnt(0)
v_max_u32 v240, v92, v93
v_max3_u32 v240, v240, v94, v95
v_cmp_eq_u32 vcc, -1, v240
s_cbranch_vccz L_rcb56
s_add_u32 s57, s57, 1
s_cmp_lt_u32 s57, 1048576
s_cbranch_scc1 L_rct55
s_branch L_end
L_slow58:
buffer_store_dword v65, v64, s[32:35], s11 offen sc1
s_branch L_back59
L_walk0_4:
s_branch L_walk0_5
L_first:
s_cmp_lg_u32 s8, 1
s_cbranch_scc1 L_firstF
v_bfe_u32 v64, v1, 4, 1
s_and_b32 s52, s6, 1
s_lshl_b32 s52, s52, 1
v_or_b32 v64, s52, v64
v_lshlrev_b32 v64, 1, v64
v_xor_b32 v64, v64, v1
v_and_b32 v64, 7, v64
v_lshlrev_b32 v64, 4, v64
v_lshrrev_b32 v65, 3, v1
s_mov_b32 s52, 9216
v_mad_u32_u24 v64, v65, s52, v64
s_mul_i32 s53, s96, 18
s_add_u32 s53, s53, s6
s_mul_i32 s53, s53, 73728
s_mul_i32 s54, s4, 1152
s_add_u32 s53, s53, s54
s_mul_i32 s54, s97, 384
s_add_u32 s53, s53, s54
s_lshl_b32 s54, s6, 10
s_add_u32 s54, s54, 65536
s_add_u32 s55, s53, 294912
s_add_u32 s56, s54, 4096
s_mov_b32 m0, s56
s_nop 0
buffer_load_dwordx4 v64, s[24:27], s55 offen nt lds
s_add_u32 s55, s53, 295040
s_add_u32 s56, s54, 22528
s_mov_b32 m0, s56
s_nop 0
buffer_load_dwordx4 v64, s[24:27], s55 offen nt lds
s_add_u32 s55, s53, 295168
s_add_u32 s56, s54, 40960
s_mov_b32 m0, s56
s_nop 0
buffer_load_dwordx4 v64, s[24:27], s55 offen nt lds
s_add_u32 s55, s53, 589824
s_add_u32 s56, s54, 8192
s_mov_b32 m0, s56
s_nop 0
buffer_load_dwordx4 v64, s[24:27], s55 offen nt lds
s_add_u32 s55, s53, 589952
s_add_u32 s56, s54, 26624
s_mov_b32 m0, s56
s_nop 0
buffer_load_dwordx4 v64, s[24:27], s55 offen nt lds
s_add_u32 s55, s53, 590080
s_add_u32 s56, s54, 45056
s_mov_b32 m0, s56
s_nop 0
buffer_load_dwordx4 v64, s[24:27], s55 offen nt lds
s_add_u32 s55, s53, 884736
s_add_u32 s56, s54, 12288
s_mov_b32 m0, s56
s_nop 0
buffer_load_dwordx4 v64, s[24:27], s55 offen nt lds
s_add_u32 s55, s53, 884864
s_add_u32 s56, s54, 30720
s_mov_b32 m0, s56
s_nop 0
buffer_load_dwordx4 v64, s[24:27], s55 offen nt lds
s_add_u32 s55, s53, 884992
s_add_u32 s56, s54, 49152
s_mov_b32 m0, s56
s_nop 0
buffer_load_dwordx4 v64, s[24:27], s55 offen nt lds
s_cmp_ge_u32 s6, 2
s_cbranch_scc1 L_w1_rest
s_add_u32 s55, s53, 1179648
s_add_u32 s56, s54, 16384
s_mov_b32 m0, s56
s_nop 0
buffer_load_dwordx4 v64, s[24:27], s55 offen nt lds
s_add_u32 s55, s53, 1179776
s_add_u32 s56, s54, 34816
s_mov_b32 m0, s56
s_nop 0
buffer_load_dwordx4 v64, s[24:27], s55 offen nt lds
s_add_u32 s55, s53, 1179904
s_add_u32 s56, s54, 53248
s_mov_b32 m0, s56
s_nop 0
buffer_load_dwordx4 v64, s[24:27], s55 offen nt lds
L_w1_rest:
v_bfe_u32 v72, v1, 3, 2
v_xor_b32 v72, s6, v72
v_lshlrev_b32 v72, 5, v72
v_and_b32 v73, 3, v1
v_lshl_add_u32 v72, v73, 3, v72
v_bfe_u32 v73, v1, 2, 2
v_lshl_add_u32 v72, v73, 7, v72
v_lshl_add_u32 v72, v3, 10, v72
v_add_u32 v72, 65536, v72
v_bfe_u32 v74, v1, 3, 1
v_and_b32 v75, 2, v3
v_or_b32 v74, v74, v75
v_xor_b32 v74, s6, v74
v_lshlrev_b32 v74, 5, v74
v_and_b32 v75, 3, v1
v_lshl_add_u32 v74, v75, 3, v74
v_lshrrev_b32 v75, 2, v1
v_lshl_add_u32 v74, v75, 7, v74
v_add_u32 v74, 81920, v74
s_waitcnt vmcnt(3)
v_mov_b32 v255, 27128
buffer_load_dword v255, v255, s[32:35], s11 offen sc1
s_waitcnt vmcnt(0)
s_barrier
ds_read_b64_tr_b16 a[84:85], v72 offset:0
ds_read_b64_tr_b16 a[86:87], v72 offset:512
ds_read_b64_tr_b16 a[88:89], v72 offset:4096
ds_read_b64_tr_b16 a[90:91], v72 offset:4608
ds_read_b64_tr_b16 a[92:93], v72 offset:8192
ds_read_b64_tr_b16 a[94:95], v72 offset:8704
ds_read_b64_tr_b16 a[96:97], v72 offset:12288
ds_read_b64_tr_b16 a[98:99], v72 offset:12800
ds_read_b64_tr_b16 a[100:101], v74 offset:0
ds_read_b64_tr_b16 a[102:103], v72 offset:18432
ds_read_b64_tr_b16 a[104:105], v72 offset:18944
ds_read_b64_tr_b16 a[106:107], v72 offset:22528
ds_read_b64_tr_b16 a[108:109], v72 offset:23040
ds_read_b64_tr_b16 a[110:111], v72 offset:26624
ds_read_b64_tr_b16 a[112:113], v72 offset:27136
ds_read_b64_tr_b16 a[114:115], v72 offset:30720
ds_read_b64_tr_b16 a[116:117], v72 offset:31232
ds_read_b64_tr_b16 a[118:119], v74 offset:18432
ds_read_b64_tr_b16 a[120:121], v72 offset:36864
ds_read_b64_tr_b16 a[122:123], v72 offset:37376
ds_read_b64_tr_b16 a[124:125], v72 offset:40960
ds_read_b64_tr_b16 a[126:127], v72 offset:41472
ds_read_b64_tr_b16 a[128:129], v72 offset:45056
ds_read_b64_tr_b16 a[130:131], v72 offset:45568
ds_read_b64_tr_b16 a[132:133], v72 offset:49152
ds_read_b64_tr_b16 a[134:135], v72 offset:49664
ds_read_b64_tr_b16 a[136:137], v74 offset:36864
v_readfirstlane_b32 s85, v255
s_lshr_b32 s53, s99, 2
s_nop 0
s_xor_b32 s53, s53, s85
s_lshl_b32 s53, s53, 13
s_cmp_lt_u32 s85, 2
s_cselect_b32 s10, s53, s10
s_mov_b32 s98, 1
s_branch L_w1_go
L_walk0_5:
s_branch L_walk0_6
L_w2_first:
s_mul_i32 s52, s4, 1152
s_mul_i32 s53, s96, 576
s_add_u32 s52, s52, s53
s_mul_i32 s53, s6, 144
s_add_u32 s52, s52, s53
v_lshl_add_u32 v64, v1, 1, s52
v_and_b32 v65, 7, v1
v_lshl_add_u32 v65, v65, 1, s52
v_mov_b32 v255, 27128
buffer_load_dword v255, v255, s[32:35], s11 offen sc1
buffer_load_dwordx4 v[92:95], v37, s[32:35], s11 offen sc1
buffer_load_ushort v24, v64, s[40:43], 0 offen
buffer_load_ushort v25, v65, s[40:43], 0 offen offset:128
v_bfe_u32 v64, v1, 4, 1
s_and_b32 s52, s6, 1
s_lshl_b32 s52, s52, 1
v_or_b32 v64, s52, v64
v_lshlrev_b32 v64, 1, v64
v_xor_b32 v64, v64, v1
v_and_b32 v64, 7, v64
v_lshlrev_b32 v64, 4, v64
v_lshrrev_b32 v65, 3, v1
s_mov_b32 s52, 1152
v_mad_u32_u24 v64, v65, s52, v64
s_lshl_b32 s53, s4, 1
s_add_u32 s53, s53, s96
s_mul_i32 s53, s53, 36
s_add_u32 s53, s53, s6
s_mul_i32 s53, s53, 9216
s_lshl_b32 s54, s97, 7
s_add_u32 s53, s53, s54
s_lshl_b32 s54, s6, 10
s_add_u32 s54, s54, 98304
s_mov_b32 m0, s54
s_nop 0
buffer_load_dwordx4 v64, s[28:31], s53 offen nt lds
s_add_u32 s53, s53, 36864
s_add_u32 s54, s54, 4096
s_mov_b32 m0, s54
s_nop 0
buffer_load_dwordx4 v64, s[28:31], s53 offen nt lds
s_add_u32 s53, s53, 36864
s_add_u32 s54, s54, 4096
s_mov_b32 m0, s54
s_nop 0
buffer_load_dwordx4 v64, s[28:31], s53 offen nt lds
s_add_u32 s53, s53, 36864
s_add_u32 s54, s54, 4096
s_mov_b32 m0, s54
s_nop 0
buffer_load_dwordx4 v64, s[28:31], s53 offen nt lds
s_add_u32 s53, s53, 36864
s_add_u32 s54, s54, 4096
s_mov_b32 m0, s54
s_nop 0
buffer_load_dwordx4 v64, s[28:31], s53 offen nt lds
s_add_u32 s53, s53, 36864
s_add_u32 s54, s54, 4096
s_mov_b32 m0, s54
s_nop 0
buffer_load_dwordx4 v64, s[28:31], s53 offen nt lds
s_add_u32 s53, s53, 36864
s_add_u32 s54, s54, 4096
s_mov_b32 m0, s54
s_nop 0
buffer_load_dwordx4 v64, s[28:31], s53 offen nt lds
s_add_u32 s53, s53, 36864
s_add_u32 s54, s54, 4096
s_mov_b32 m0, s54
s_nop 0
buffer_load_dwordx4 v64, s[28:31], s53 offen nt lds
s_add_u32 s53, s53, 36864
s_add_u32 s54, s54, 4096
s_mov_b32 m0, s54
s_nop 0
buffer_load_dwordx4 v64, s[28:31], s53 offen nt lds
v_add_u32 v66, 9216, v54
v_sub_u32 v67, v66, v54
v_add_u32 v67, v67, v55
v_cmp_gt_u32 vcc, 8, v2
s_nop 1
v_cndmask_b32 v67, v66, v67, vcc
v_bfe_u32 v64, v1, 3, 2
v_xor_b32 v64, s6, v64
v_lshlrev_b32 v64, 5, v64
v_and_b32 v65, 3, v1
v_lshl_add_u32 v64, v65, 3, v64
v_bfe_u32 v65, v1, 2, 2
v_lshl_add_u32 v64, v65, 7, v64
v_lshl_add_u32 v64, v3, 10, v64
v_add_u32 v64, 98304, v64
s_waitcnt vmcnt(11)
v_readfirstlane_b32 s85, v255
s_lshr_b32 s53, s99, 2
s_nop 0
s_xor_b32 s53, s53, s85
s_lshl_b32 s53, s53, 13
s_cmp_lt_u32 s85, 2
s_cselect_b32 s10, s53, s10
v_max_u32 v240, v92, v93
v_max3_u32 v240, v240, v94, v95
v_cmp_eq_u32 vcc, -1, v240
s_cbranch_vccnz L_rc54
L_rcb56:
v_add_f32 v240, v92, v93
v_add_f32 v241, v94, v95
v_add_f32 v240, v240, v241
v_cvt_pk_bf16_f32 v241, v240, v240
v_lshlrev_b32 v242, 16, v241
v_sub_f32 v240, v240, v242
v_cvt_pk_bf16_f32 v240, v240, v240
ds_write_b16 v39, v241 offset:1600
ds_write_b16 v39, v240 offset:2400
s_add_u32 s59, s7, s10
s_waitcnt vmcnt(0)
s_barrier
v_mov_b32 v60, 27128
buffer_load_dword v60, v60, s[32:35], s11 offen sc1
ds_read_b64_tr_b16 a[116:117], v64 offset:0
ds_read_b64_tr_b16 a[118:119], v64 offset:512
ds_read_b64_tr_b16 a[120:121], v64 offset:4096
ds_read_b64_tr_b16 a[122:123], v64 offset:4608
ds_read_b64_tr_b16 a[124:125], v64 offset:8192
ds_read_b64_tr_b16 a[126:127], v64 offset:8704
ds_read_b64_tr_b16 a[128:129], v64 offset:12288
ds_read_b64_tr_b16 a[130:131], v64 offset:12800
ds_read_b64_tr_b16 a[132:133], v64 offset:16384
ds_read_b64_tr_b16 a[134:135], v64 offset:16896
ds_read_b64_tr_b16 a[136:137], v64 offset:20480
ds_read_b64_tr_b16 a[138:139], v64 offset:20992
ds_read_b64_tr_b16 a[140:141], v64 offset:24576
ds_read_b64_tr_b16 a[142:143], v64 offset:25088
ds_read_b64_tr_b16 a[144:145], v64 offset:28672
ds_read_b64_tr_b16 a[146:147], v64 offset:29184
ds_read_b64_tr_b16 a[148:149], v64 offset:32768
ds_read_b64_tr_b16 a[150:151], v64 offset:33280
v_lshlrev_b32 v24, 16, v24
v_lshlrev_b32 v25, 16, v25
s_mov_b32 s57, 0
buffer_load_dwordx4 v[224:227], v54, s[32:35], s58 offen sc1
buffer_load_dwordx4 v[228:231], v55, s[32:35], s58 offen sc1
buffer_load_dwordx4 v[212:215], v66, s[32:35], s58 offen sc1
buffer_load_dwordx4 v[216:219], v67, s[32:35], s58 offen sc1
s_nop 7
s_nop 7
s_nop 7
L_poll57:
buffer_load_dwordx4 v[224:227], v54, s[32:35], s58 offen sc1
buffer_load_dwordx4 v[228:231], v55, s[32:35], s58 offen sc1
buffer_load_dwordx4 v[212:215], v66, s[32:35], s58 offen sc1
buffer_load_dwordx4 v[216:219], v67, s[32:35], s58 offen sc1
s_add_u32 s57, s57, 1
s_cmp_gt_u32 s57, 1048576
s_cbranch_scc1 L_end
s_waitcnt vmcnt(4)
v_max_u32 v240, v224, v225
v_max3_u32 v240, v240, v226, v227
v_max3_u32 v240, v240, v228, v229
v_max3_u32 v240, v240, v230, v231
v_max3_u32 v240, v240, v212, v213
v_max3_u32 v240, v240, v214, v215
v_max3_u32 v240, v240, v216, v217
v_max3_u32 v240, v240, v218, v219
v_cmp_eq_u32 vcc, -1, v240
s_cbranch_vccnz L_poll57
v_add_f32 v26, v212, v213
v_add_f32 v240, v214, v215
v_add_f32 v27, v216, v217
v_add_f32 v241, v218, v219
v_add_f32 v26, v26, v240
v_add_f32 v27, v27, v241
s_branch L_w2_ok
L_walk0_6:
s_branch L_walk0_7
L_a_first:
v_mov_b32 v255, v60
s_nop 0
v_readfirstlane_b32 s85, v255
s_lshr_b32 s53, s99, 2
s_nop 0
s_xor_b32 s53, s53, s85
s_lshl_b32 s53, s53, 13
s_cmp_lt_u32 s85, 2
s_cselect_b32 s10, s53, s10
s_branch L_q
L_walk0_7:
s_branch L_walked
L_firstF:
s_cmp_eq_u32 s5, 31
s_cbranch_scc1 L_f31
s_lshl_b32 s53, s6, 11
s_and_b32 s52, s6, 1
s_lshl_b32 s52, s52, 13
s_add_u32 s52, s52, s53
s_add_u32 s56, s52, 1835008
s_mov_b32 s84, -1
s_mov_b32 s85, -1
s_xor_b32 s52, s56, 0
s_memtime s[100:101]
s_waitcnt lgkmcnt(0)
s_buffer_load_dword s101, s[32:35], s52
s_waitcnt lgkmcnt(0)
s_memtime s[54:55]
s_waitcnt lgkmcnt(0)
s_sub_u32 s54, s54, s100
s_min_u32 s84, s84, s54
s_xor_b32 s52, s56, 8192
s_memtime s[100:101]
s_waitcnt lgkmcnt(0)
s_buffer_load_dword s101, s[32:35], s52
s_waitcnt lgkmcnt(0)
s_memtime s[54:55]
s_waitcnt lgkmcnt(0)
s_sub_u32 s54, s54, s100
s_min_u32 s85, s85, s54
s_xor_b32 s52, s56, 128
s_memtime s[100:101]
s_waitcnt lgkmcnt(0)
s_buffer_load_dword s101, s[32:35], s52
s_waitcnt lgkmcnt(0)
s_memtime s[54:55]
s_waitcnt lgkmcnt(0)
s_sub_u32 s54, s54, s100
s_min_u32 s84, s84, s54
s_bitcmp1_b32 s6, 0
s_cselect_b32 s52, s85, s84
s_cselect_b32 s85, s84, s85
s_mov_b32 s84, s52
s_lshl_b32 s53, s6, 2
s_add_u32 s53, s53, 158784
v_mov_b32 v64, s53
v_mov_b32 v65, s84
v_mov_b32 v66, s85
ds_write2_b32 v64, v65, v66 offset0:0 offset1:4
s_waitcnt lgkmcnt(0)
s_barrier
v_mov_b32 v64, 158784
ds_read_b128 v[92:95], v64
ds_read_b128 v[96:99], v64 offset:16
s_waitcnt lgkmcnt(0)
v_min_u32 v64, v92, v93
v_min3_u32 v64, v64, v94, v95
v_min_u32 v65, v96, v97
v_min3_u32 v65, v65, v98, v99
v_cmp_gt_u32 vcc, v64, v65
s_lshr_b32 s52, s99, 2
s_cmp_lg_u32 vcc_lo, 0
s_cselect_b32 s56, 1, 0
s_xor_b32 s56, s56, s52
s_sub_u32 s52, s5, 30
s_lshl_b32 s52, s52, 2
s_add_u32 s52, s52, 27128
v_mov_b32 v64, s52
v_mov_b32 v65, s56
s_cmp_eq_u32 s9, 0
s_mov_b64 exec, s[70:71]
s_cbranch_scc1 L_slow58
buffer_store_dword v65, v64, s[32:35], s11 offen
L_back59:
s_mov_b64 exec, -1
s_branch L_bf_first
L_f31:
v_mov_b32 v76, -1
v_mov_b32 v77, -1
v_mov_b32 v78, -1
v_mov_b32 v79, -1
v_lshlrev_b32 v66, 4, v0
s_add_u32 s52, s11, 1048576
buffer_store_dwordx4 v[76:79], v66, s[32:35], s52 offen sc1
s_add_u32 s52, s52, 4096
buffer_store_dwordx4 v[76:79], v66, s[32:35], s52 offen sc1
s_add_u32 s52, s52, 4096
buffer_store_dwordx4 v[76:79], v66, s[32:35], s52 offen sc1
s_add_u32 s52, s52, 4096
buffer_store_dwordx4 v[76:79], v66, s[32:35], s52 offen sc1
s_add_u32 s52, s52, 4096
buffer_store_dwordx4 v[76:79], v66, s[32:35], s52 offen sc1
s_add_u32 s52, s52, 4096
buffer_store_dwordx4 v[76:79], v66, s[32:35], s52 offen sc1
s_add_u32 s52, s52, 4096
buffer_store_dwordx4 v[76:79], v66, s[32:35], s52 offen sc1
s_add_u32 s52, s52, 4096
buffer_store_dwordx4 v[76:79], v66, s[32:35], s52 offen sc1
s_add_u32 s52, s52, 4096
buffer_store_dwordx4 v[76:79], v66, s[32:35], s52 offen sc1
s_add_u32 s52, s52, 4096
buffer_store_dwordx4 v[76:79], v66, s[32:35], s52 offen sc1
s_add_u32 s52, s52, 4096
buffer_store_dwordx4 v[76:79], v66, s[32:35], s52 offen sc1
s_add_u32 s52, s52, 4096
s_cmp_ge_u32 s6, 2
s_cbranch_scc1 L_lf5
buffer_store_dwordx4 v[76:79], v66, s[32:35], s52 offen sc1
s_add_u32 s52, s52, 4096
L_lf5:
s_lshl_b32 s52, s4, 14
s_add_u32 s52, s52, 1048576
s_and_b32 s53, s6, 1
s_cselect_b64 exec, 0xff, -1
buffer_store_dwordx4 v[76:79], v66, s[32:35], s52 offen sc1
s_add_u32 s52, s52, 4096
buffer_store_dwordx4 v[76:79], v66, s[32:35], s52 offen sc1
s_add_u32 s52, s52, 4096
buffer_store_dwordx4 v[76:79], v66, s[32:35], s52 offen sc1
s_add_u32 s52, s52, 4096
buffer_store_dwordx4 v[76:79], v66, s[32:35], s52 offen sc1
s_add_u32 s52, s52, 4096
s_mov_b64 exec, -1
s_lshl_b32 s56, s4, 2
s_add_u32 s56, s56, 1785856
v_lshl_add_u32 v67, v1, 13, s56
v_mov_b32 v68, s68
s_waitcnt vmcnt(0)
s_barrier
s_cmp_eq_u32 s6, 0
s_cselect_b64 exec, 3, 0
buffer_store_dword v68, v67, s[32:35], 0 offen sc1
s_mov_b64 exec, -1
v_lshlrev_b32 v66, 7, v0
s_add_u32 s52, s11, 1048576
buffer_load_dword v8, v66, s[32:35], s52 offen sc1
s_add_u32 s52, s52, 0x8000
v_cmp_gt_u32 vcc, 112, v0
s_and_saveexec_b64 s[54:55], vcc
s_cbranch_execz L_lf6
buffer_load_dword v8, v66, s[32:35], s52 offen sc1
L_lf6:
s_mov_b64 exec, -1
v_mov_b32 v64, 983040
v_mov_b32 v65, s68
s_lshl_b32 s52, s2, 2
s_add_u32 s52, s52, s6
s_cmp_eq_u32 s52, 1020
s_cselect_b64 exec, 1, 0
buffer_store_dword v65, v64, s[32:35], 0 offen sc1
s_mov_b64 exec, -1
L_bf_first:
v_mov_b32 v47, 0
v_mov_b32 v255, 27128
buffer_load_dword v255, v255, s[32:35], s11 offen sc1
s_mov_b32 s57, 0
L_poll60:
buffer_load_dwordx4 v[92:95], v37, s[32:35], s11 offen sc1
s_add_u32 s57, s57, 1
s_cmp_gt_u32 s57, 1048576
s_cbranch_scc1 L_end
s_waitcnt vmcnt(0)
v_max_u32 v240, v92, v93
v_max3_u32 v240, v240, v94, v95
v_cmp_eq_u32 vcc, -1, v240
s_cbranch_vccnz L_poll60
v_add_f32 v240, v92, v93
v_add_f32 v241, v94, v95
v_add_f32 v240, v240, v241
v_cvt_pk_bf16_f32 v241, v240, v240
v_lshlrev_b32 v242, 16, v241
v_sub_f32 v240, v240, v242
v_cvt_pk_bf16_f32 v240, v240, v240
ds_write_b16 v39, v241 offset:1600
ds_write_b16 v39, v240 offset:2400
v_readfirstlane_b32 s85, v255
s_lshr_b32 s53, s99, 2
s_nop 0
s_xor_b32 s53, s53, s85
s_lshl_b32 s53, s53, 13
s_cmp_lt_u32 s85, 2
s_cselect_b32 s10, s53, s10
s_branch L_q
.p2align 8
.fill 1024, 4, 0xbf800000
s_endpgm

.section .rodata,"a"
.p2align 6
.amdhsa_kernel interleave_layers__sliding_block_cached__dense_activation_mish__decode_kernel
  .amdhsa_next_free_vgpr 416
  .amdhsa_next_free_sgpr 102
  .amdhsa_accum_offset 256
  .amdhsa_group_segment_fixed_size 0
  .amdhsa_kernarg_size 96
  .amdhsa_user_sgpr_count 2
  .amdhsa_user_sgpr_kernarg_segment_ptr 1
  .amdhsa_system_sgpr_workgroup_id_x 1
  .amdhsa_float_denorm_mode_32 3
.end_amdhsa_kernel
```
